```python
import torch

def _softmax(x, axis=-1):
    return torch.softmax(x, dim=axis)
def _gelu(x):
    return torch.nn.functional.gelu(x, approximate="tanh")
def _silu(x):
    return torch.nn.functional.silu(x)
def _sigmoid(x):
    return torch.sigmoid(x)
def _layernorm(x, axis=-1, eps=1e-5):
    m = x.mean(dim=axis, keepdim=True)
    v = x.var(dim=axis, keepdim=True, unbiased=False)
    return (x - m) / torch.sqrt(v + eps)
def _scatter_add(tgt, idx, src, axis=0):
    return tgt.clone().index_add_(axis, idx, src)
def _segment_sum(src, seg, n):
    out = torch.zeros((n,) + src.shape[1:], dtype=src.dtype)
    return out.index_add_(0, seg, src)
def _pad(x, pw):
    flat = tuple(v for pair in reversed(pw) for v in pair)
    return torch.nn.functional.pad(x, flat)

kernel_name = 'sequential_preLN__softmax_full_mha__mixer_s_mlp__prompt'

def setup_inputs():

    _w = (lambda a: (lambda t: t.to(torch.bfloat16) if t.is_floating_point() else t)(torch.as_tensor(a)))
    def _A_setup():
        B, S, D = 1, 2048, 512
        return {
            "x": _w((lambda *s: torch.randn(*s, dtype=torch.bfloat16) * 0.05)(B, S, D)),
            "wqkv": _w((lambda *s: torch.randn(*s, dtype=torch.bfloat16) * 0.05)(D, 3 * D)),
            "wo": _w((lambda *s: torch.randn(*s, dtype=torch.bfloat16) * 0.05)(D, D)),
        }
    _A_in = _A_setup()

    def _B_setup():
        B, S, D, F = 1, 2048, 512, 1376
        return {
            "x":  _w((lambda *s: torch.randn(*s, dtype=torch.bfloat16) * 0.05)(B, S, D)),
            "w1": _w((lambda *s: torch.randn(*s, dtype=torch.bfloat16) * 3.2)(D, D) * (D ** -0.5)),
            "w2": _w((lambda *s: torch.randn(*s, dtype=torch.bfloat16) * 3.2)(D, D) * (D ** -0.5)),
            "w3": _w((lambda *s: torch.randn(*s, dtype=torch.bfloat16) * 3.2)(D, F) * (D ** -0.5)),
            "w4": _w((lambda *s: torch.randn(*s, dtype=torch.bfloat16) * 3.2)(F, D) * (F ** -0.5)),
        }
    _B_in = _B_setup()

    return {
        "A_x": _A_in["x"],
        "A_wqkv": _A_in["wqkv"],
        "A_wo": _A_in["wo"],
        "B_x": _B_in["x"],
        "B_w1": _B_in["w1"],
        "B_w2": _B_in["w2"],
        "B_w3": _B_in["w3"],
        "B_w4": _B_in["w4"],
    }

def reference(A_x, A_wqkv, A_wo, B_x, B_w1, B_w2, B_w3, B_w4):
    def _A_ref(x, wqkv, wo):
        B, S, D = x.shape
        H = 32; Dh = D // H
        qkv = (lambda x, *d: x.permute(*d))((x @ wqkv).reshape(B, S, 3, H, Dh), 2, 0, 3, 1, 4)
        q, k, v = qkv[0], qkv[1], qkv[2]
        scale = Dh ** -0.5
        scores = torch.einsum("bhqd,bhkd->bhqk", q, k) * scale
        p = _softmax(scores, axis=-1)
        o = torch.einsum("bhqk,bhkd->bhqd", p, v)
        return (lambda x, *d: x.permute(*d))(o, 0, 2, 1, 3).reshape(B, S, D) @ wo

    def _B_ref(x, w1, w2, w3, w4):
        B, S, D = x.shape
        h = _gelu(_layernorm(x, axis=-1) @ w1)
        c = D // 4
        g0 = _pad(h[:, :, 0*c:1*c], ((0, 0), (1, 0), (0, 0)))[:, :S, :]
        g1 = _pad(h[:, :, 1*c:2*c], ((0, 0), (0, 1), (0, 0)))[:, 1:, :]
        g2 = _pad(h[:, :, 2*c:3*c], ((0, 0), (2, 0), (0, 0)))[:, :S, :]
        g3 = _pad(h[:, :, 3*c:   ], ((0, 0), (0, 2), (0, 0)))[:, 2:, :]
        hs = torch.concatenate([g0, g1, g2, g3], axis=-1) @ w2
        x1 = x + hs
        h2 = _gelu(_layernorm(x1, axis=-1) @ w3) @ w4
        return x1 + h2

    x = A_x
    h = x + _A_ref(_layernorm(x, axis=-1), A_wqkv, A_wo)
    h2 = h + _B_ref(_layernorm(h, axis=-1), B_w1, B_w2, B_w3, B_w4)
    return h2
```

```asm
; @launch kernel=k1_kernel grid=(768,1,1) block=(256,1,1) lds=65536
; @launch kernel=k2attn_kernel grid=(256,1,1) block=(512,1,1) lds=131584
; @launch kernel=k3_kernel grid=(256,1,1) block=(256,1,1) lds=65536
; @launch kernel=k4_kernel grid=(256,1,1) block=(256,1,1) lds=65536
; @launch kernel=k5_kernel grid=(256,1,1) block=(256,1,1) lds=65536
; @launch kernel=k6_kernel grid=(704,1,1) block=(256,1,1) lds=65536
; @launch kernel=k7_kernel grid=(256,1,1) block=(256,1,1) lds=65536
.amdgcn_target "amdgcn-amd-amdhsa--gfx950"
.text
.globl k1_kernel
.p2align 8
.type k1_kernel,@function
k1_kernel:
    s_cmp_lt_u32 s2, 512
    s_cbranch_scc1 k1qk
    s_sub_u32 s2, s2, 512
    s_branch k1v
k1qk:
    s_and_b32 s3, s2, 63
    s_lshr_b32 s4, s2, 6
    s_cmp_ge_u32 s4, 8
    s_cbranch_scc1 L_end_k1qk
    s_load_dwordx2 s[6:7], s[0:1], 80
    s_load_dwordx2 s[8:9], s[0:1], 8
    s_load_dwordx2 s[10:11], s[0:1], 0
    s_load_dwordx2 s[12:13], s[0:1], 64
    v_lshrrev_b32 v1, 6, v0
    v_and_b32 v2, 63, v0
    v_and_b32 v3, 31, v2
    v_lshrrev_b32 v4, 5, v2
    v_readfirstlane_b32 s5, v1
    s_mov_b32 s40, 0x05040100
    s_mov_b32 s41, 0x07060302
    s_waitcnt lgkmcnt(0)
    s_mov_b32 s16, s10
    s_mov_b32 s17, s11
    s_mov_b32 s18, 0x200000
    s_mov_b32 s19, 0x00020000
    s_mov_b32 s20, s8
    s_mov_b32 s21, s9
    s_mov_b32 s22, 0x180000
    s_mov_b32 s23, 0x00020000
    s_lshl_b32 s24, s3, 5
    s_mul_i32 s25, s5, 8
    s_lshl_b32 s26, s4, 8
    s_mul_i32 s27, s25, 49152
    s_add_u32 s26, s26, s27
    v_mul_u32_u24 v5, 24576, v4
    v_lshl_add_u32 v5, v3, 3, v5
    v_lshrrev_b32 v6, 3, v0
    v_and_b32 v7, 7, v0
    v_add_u32 v8, s24, v6
    v_mul_u32_u24 v8, 1024, v8
    v_lshl_add_u32 v8, v7, 4, v8
    buffer_load_dwordx4 v[16:19], v8, s[16:19], 0 offen offset:0
    buffer_load_dwordx4 v[20:23], v8, s[16:19], 0 offen offset:128
    buffer_load_dwordx4 v[24:27], v8, s[16:19], 0 offen offset:256
    buffer_load_dwordx4 v[28:31], v8, s[16:19], 0 offen offset:384
    buffer_load_dwordx4 v[32:35], v8, s[16:19], 0 offen offset:512
    buffer_load_dwordx4 v[36:39], v8, s[16:19], 0 offen offset:640
    buffer_load_dwordx4 v[40:43], v8, s[16:19], 0 offen offset:768
    buffer_load_dwordx4 v[44:47], v8, s[16:19], 0 offen offset:896
    buffer_load_dwordx2 v[128:129], v5, s[20:23], s26 offen offset:0
    buffer_load_dwordx2 v[130:131], v5, s[20:23], s26 offen offset:3072
    s_add_u32 s28, s26, 0x1800
    buffer_load_dwordx2 v[132:133], v5, s[20:23], s28 offen
    s_add_u32 s28, s26, 0x2400
    buffer_load_dwordx2 v[134:135], v5, s[20:23], s28 offen
    s_add_u32 s28, s26, 0x3000
    buffer_load_dwordx2 v[136:137], v5, s[20:23], s28 offen
    s_add_u32 s28, s26, 0x3c00
    buffer_load_dwordx2 v[138:139], v5, s[20:23], s28 offen
    s_add_u32 s28, s26, 0x4800
    buffer_load_dwordx2 v[140:141], v5, s[20:23], s28 offen
    s_add_u32 s28, s26, 0x5400
    buffer_load_dwordx2 v[142:143], v5, s[20:23], s28 offen
    s_add_u32 s28, s26, 0xc000
    buffer_load_dwordx2 v[144:145], v5, s[20:23], s28 offen
    s_add_u32 s28, s26, 0xcc00
    buffer_load_dwordx2 v[146:147], v5, s[20:23], s28 offen
    s_add_u32 s28, s26, 0xd800
    buffer_load_dwordx2 v[148:149], v5, s[20:23], s28 offen
    s_add_u32 s28, s26, 0xe400
    buffer_load_dwordx2 v[150:151], v5, s[20:23], s28 offen
    s_add_u32 s28, s26, 0xf000
    buffer_load_dwordx2 v[152:153], v5, s[20:23], s28 offen
    s_add_u32 s28, s26, 0xfc00
    buffer_load_dwordx2 v[154:155], v5, s[20:23], s28 offen
    s_add_u32 s28, s26, 0x10800
    buffer_load_dwordx2 v[156:157], v5, s[20:23], s28 offen
    s_add_u32 s28, s26, 0x11400
    buffer_load_dwordx2 v[158:159], v5, s[20:23], s28 offen
    s_add_u32 s28, s26, 0x18000
    buffer_load_dwordx2 v[160:161], v5, s[20:23], s28 offen
    s_add_u32 s28, s26, 0x18c00
    buffer_load_dwordx2 v[162:163], v5, s[20:23], s28 offen
    s_add_u32 s28, s26, 0x19800
    buffer_load_dwordx2 v[164:165], v5, s[20:23], s28 offen
    s_add_u32 s28, s26, 0x1a400
    buffer_load_dwordx2 v[166:167], v5, s[20:23], s28 offen
    s_add_u32 s28, s26, 0x1b000
    buffer_load_dwordx2 v[168:169], v5, s[20:23], s28 offen
    s_add_u32 s28, s26, 0x1bc00
    buffer_load_dwordx2 v[170:171], v5, s[20:23], s28 offen
    s_add_u32 s28, s26, 0x1c800
    buffer_load_dwordx2 v[172:173], v5, s[20:23], s28 offen
    s_add_u32 s28, s26, 0x1d400
    buffer_load_dwordx2 v[174:175], v5, s[20:23], s28 offen
    s_add_u32 s28, s26, 0x24000
    buffer_load_dwordx2 v[176:177], v5, s[20:23], s28 offen
    s_add_u32 s28, s26, 0x24c00
    buffer_load_dwordx2 v[178:179], v5, s[20:23], s28 offen
    s_add_u32 s28, s26, 0x25800
    buffer_load_dwordx2 v[180:181], v5, s[20:23], s28 offen
    s_add_u32 s28, s26, 0x26400
    buffer_load_dwordx2 v[182:183], v5, s[20:23], s28 offen
    s_add_u32 s28, s26, 0x27000
    buffer_load_dwordx2 v[184:185], v5, s[20:23], s28 offen
    s_add_u32 s28, s26, 0x27c00
    buffer_load_dwordx2 v[186:187], v5, s[20:23], s28 offen
    s_add_u32 s28, s26, 0x28800
    buffer_load_dwordx2 v[188:189], v5, s[20:23], s28 offen
    s_add_u32 s28, s26, 0x29400
    buffer_load_dwordx2 v[190:191], v5, s[20:23], s28 offen
    s_waitcnt vmcnt(32)
    s_add_u32 s28, s26, 0x30000
    buffer_load_dwordx2 v[192:193], v5, s[20:23], s28 offen
    s_add_u32 s28, s26, 0x30c00
    buffer_load_dwordx2 v[194:195], v5, s[20:23], s28 offen
    s_add_u32 s28, s26, 0x31800
    buffer_load_dwordx2 v[196:197], v5, s[20:23], s28 offen
    s_add_u32 s28, s26, 0x32400
    buffer_load_dwordx2 v[198:199], v5, s[20:23], s28 offen
    s_add_u32 s28, s26, 0x33000
    buffer_load_dwordx2 v[200:201], v5, s[20:23], s28 offen
    s_add_u32 s28, s26, 0x33c00
    buffer_load_dwordx2 v[202:203], v5, s[20:23], s28 offen
    s_add_u32 s28, s26, 0x34800
    buffer_load_dwordx2 v[204:205], v5, s[20:23], s28 offen
    s_add_u32 s28, s26, 0x35400
    buffer_load_dwordx2 v[206:207], v5, s[20:23], s28 offen
    s_add_u32 s28, s26, 0x3c000
    buffer_load_dwordx2 v[208:209], v5, s[20:23], s28 offen
    s_add_u32 s28, s26, 0x3cc00
    buffer_load_dwordx2 v[210:211], v5, s[20:23], s28 offen
    s_add_u32 s28, s26, 0x3d800
    buffer_load_dwordx2 v[212:213], v5, s[20:23], s28 offen
    s_add_u32 s28, s26, 0x3e400
    buffer_load_dwordx2 v[214:215], v5, s[20:23], s28 offen
    s_add_u32 s28, s26, 0x3f000
    buffer_load_dwordx2 v[216:217], v5, s[20:23], s28 offen
    s_add_u32 s28, s26, 0x3fc00
    buffer_load_dwordx2 v[218:219], v5, s[20:23], s28 offen
    s_add_u32 s28, s26, 0x40800
    buffer_load_dwordx2 v[220:221], v5, s[20:23], s28 offen
    s_add_u32 s28, s26, 0x41400
    buffer_load_dwordx2 v[222:223], v5, s[20:23], s28 offen
    s_add_u32 s28, s26, 0x48000
    buffer_load_dwordx2 v[224:225], v5, s[20:23], s28 offen
    s_add_u32 s28, s26, 0x48c00
    buffer_load_dwordx2 v[226:227], v5, s[20:23], s28 offen
    s_add_u32 s28, s26, 0x49800
    buffer_load_dwordx2 v[228:229], v5, s[20:23], s28 offen
    s_add_u32 s28, s26, 0x4a400
    buffer_load_dwordx2 v[230:231], v5, s[20:23], s28 offen
    s_add_u32 s28, s26, 0x4b000
    buffer_load_dwordx2 v[232:233], v5, s[20:23], s28 offen
    s_add_u32 s28, s26, 0x4bc00
    buffer_load_dwordx2 v[234:235], v5, s[20:23], s28 offen
    s_add_u32 s28, s26, 0x4c800
    buffer_load_dwordx2 v[236:237], v5, s[20:23], s28 offen
    s_add_u32 s28, s26, 0x4d400
    buffer_load_dwordx2 v[238:239], v5, s[20:23], s28 offen
    s_add_u32 s28, s26, 0x54000
    buffer_load_dwordx2 v[240:241], v5, s[20:23], s28 offen
    s_add_u32 s28, s26, 0x54c00
    buffer_load_dwordx2 v[242:243], v5, s[20:23], s28 offen
    s_add_u32 s28, s26, 0x55800
    buffer_load_dwordx2 v[244:245], v5, s[20:23], s28 offen
    s_add_u32 s28, s26, 0x56400
    buffer_load_dwordx2 v[246:247], v5, s[20:23], s28 offen
    s_add_u32 s28, s26, 0x57000
    buffer_load_dwordx2 v[248:249], v5, s[20:23], s28 offen
    s_add_u32 s28, s26, 0x57c00
    buffer_load_dwordx2 v[250:251], v5, s[20:23], s28 offen
    s_add_u32 s28, s26, 0x58800
    buffer_load_dwordx2 v[252:253], v5, s[20:23], s28 offen
    s_add_u32 s28, s26, 0x59400
    buffer_load_dwordx2 v[254:255], v5, s[20:23], s28 offen
    v_lshlrev_b32 v48, 16, v16
    v_and_b32 v49, 0xffff0000, v16
    v_lshlrev_b32 v50, 16, v17
    v_and_b32 v51, 0xffff0000, v17
    v_lshlrev_b32 v52, 16, v18
    v_and_b32 v53, 0xffff0000, v18
    v_lshlrev_b32 v54, 16, v19
    v_and_b32 v55, 0xffff0000, v19
    v_lshlrev_b32 v56, 16, v20
    v_and_b32 v57, 0xffff0000, v20
    v_lshlrev_b32 v58, 16, v21
    v_and_b32 v59, 0xffff0000, v21
    v_lshlrev_b32 v60, 16, v22
    v_and_b32 v61, 0xffff0000, v22
    v_lshlrev_b32 v62, 16, v23
    v_and_b32 v63, 0xffff0000, v23
    v_lshlrev_b32 v64, 16, v24
    v_and_b32 v65, 0xffff0000, v24
    v_lshlrev_b32 v66, 16, v25
    v_and_b32 v67, 0xffff0000, v25
    v_lshlrev_b32 v68, 16, v26
    v_and_b32 v69, 0xffff0000, v26
    v_lshlrev_b32 v70, 16, v27
    v_and_b32 v71, 0xffff0000, v27
    v_lshlrev_b32 v72, 16, v28
    v_and_b32 v73, 0xffff0000, v28
    v_lshlrev_b32 v74, 16, v29
    v_and_b32 v75, 0xffff0000, v29
    v_lshlrev_b32 v76, 16, v30
    v_and_b32 v77, 0xffff0000, v30
    v_lshlrev_b32 v78, 16, v31
    v_and_b32 v79, 0xffff0000, v31
    v_lshlrev_b32 v80, 16, v32
    v_and_b32 v81, 0xffff0000, v32
    v_lshlrev_b32 v82, 16, v33
    v_and_b32 v83, 0xffff0000, v33
    v_lshlrev_b32 v84, 16, v34
    v_and_b32 v85, 0xffff0000, v34
    v_lshlrev_b32 v86, 16, v35
    v_and_b32 v87, 0xffff0000, v35
    v_lshlrev_b32 v88, 16, v36
    v_and_b32 v89, 0xffff0000, v36
    v_lshlrev_b32 v90, 16, v37
    v_and_b32 v91, 0xffff0000, v37
    v_lshlrev_b32 v92, 16, v38
    v_and_b32 v93, 0xffff0000, v38
    v_lshlrev_b32 v94, 16, v39
    v_and_b32 v95, 0xffff0000, v39
    v_lshlrev_b32 v96, 16, v40
    v_and_b32 v97, 0xffff0000, v40
    v_lshlrev_b32 v98, 16, v41
    v_and_b32 v99, 0xffff0000, v41
    v_lshlrev_b32 v100, 16, v42
    v_and_b32 v101, 0xffff0000, v42
    v_lshlrev_b32 v102, 16, v43
    v_and_b32 v103, 0xffff0000, v43
    v_lshlrev_b32 v104, 16, v44
    v_and_b32 v105, 0xffff0000, v44
    v_lshlrev_b32 v106, 16, v45
    v_and_b32 v107, 0xffff0000, v45
    v_lshlrev_b32 v108, 16, v46
    v_and_b32 v109, 0xffff0000, v46
    v_lshlrev_b32 v110, 16, v47
    v_and_b32 v111, 0xffff0000, v47
    v_add_f32 v9, v48, v49
    v_add_f32 v9, v9, v50
    v_add_f32 v9, v9, v51
    v_add_f32 v9, v9, v52
    v_add_f32 v9, v9, v53
    v_add_f32 v9, v9, v54
    v_add_f32 v9, v9, v55
    v_add_f32 v9, v9, v56
    v_add_f32 v9, v9, v57
    v_add_f32 v9, v9, v58
    v_add_f32 v9, v9, v59
    v_add_f32 v9, v9, v60
    v_add_f32 v9, v9, v61
    v_add_f32 v9, v9, v62
    v_add_f32 v9, v9, v63
    v_add_f32 v9, v9, v64
    v_add_f32 v9, v9, v65
    v_add_f32 v9, v9, v66
    v_add_f32 v9, v9, v67
    v_add_f32 v9, v9, v68
    v_add_f32 v9, v9, v69
    v_add_f32 v9, v9, v70
    v_add_f32 v9, v9, v71
    v_add_f32 v9, v9, v72
    v_add_f32 v9, v9, v73
    v_add_f32 v9, v9, v74
    v_add_f32 v9, v9, v75
    v_add_f32 v9, v9, v76
    v_add_f32 v9, v9, v77
    v_add_f32 v9, v9, v78
    v_add_f32 v9, v9, v79
    v_add_f32 v9, v9, v80
    v_add_f32 v9, v9, v81
    v_add_f32 v9, v9, v82
    v_add_f32 v9, v9, v83
    v_add_f32 v9, v9, v84
    v_add_f32 v9, v9, v85
    v_add_f32 v9, v9, v86
    v_add_f32 v9, v9, v87
    v_add_f32 v9, v9, v88
    v_add_f32 v9, v9, v89
    v_add_f32 v9, v9, v90
    v_add_f32 v9, v9, v91
    v_add_f32 v9, v9, v92
    v_add_f32 v9, v9, v93
    v_add_f32 v9, v9, v94
    v_add_f32 v9, v9, v95
    v_add_f32 v9, v9, v96
    v_add_f32 v9, v9, v97
    v_add_f32 v9, v9, v98
    v_add_f32 v9, v9, v99
    v_add_f32 v9, v9, v100
    v_add_f32 v9, v9, v101
    v_add_f32 v9, v9, v102
    v_add_f32 v9, v9, v103
    v_add_f32 v9, v9, v104
    v_add_f32 v9, v9, v105
    v_add_f32 v9, v9, v106
    v_add_f32 v9, v9, v107
    v_add_f32 v9, v9, v108
    v_add_f32 v9, v9, v109
    v_add_f32 v9, v9, v110
    v_add_f32 v9, v9, v111
    s_nop 1
    v_add_f32_dpp v9, v9, v9 quad_perm:[1,0,3,2] row_mask:0xf bank_mask:0xf
    s_nop 1
    v_add_f32_dpp v9, v9, v9 quad_perm:[2,3,0,1] row_mask:0xf bank_mask:0xf
    s_nop 1
    v_add_f32_dpp v9, v9, v9 row_half_mirror row_mask:0xf bank_mask:0xf
    v_mul_f32 v9, 0x3b000000, v9
    v_sub_f32 v48, v48, v9
    v_sub_f32 v49, v49, v9
    v_sub_f32 v50, v50, v9
    v_sub_f32 v51, v51, v9
    v_sub_f32 v52, v52, v9
    v_sub_f32 v53, v53, v9
    v_sub_f32 v54, v54, v9
    v_sub_f32 v55, v55, v9
    v_sub_f32 v56, v56, v9
    v_sub_f32 v57, v57, v9
    v_sub_f32 v58, v58, v9
    v_sub_f32 v59, v59, v9
    v_sub_f32 v60, v60, v9
    v_sub_f32 v61, v61, v9
    v_sub_f32 v62, v62, v9
    v_sub_f32 v63, v63, v9
    v_sub_f32 v64, v64, v9
    v_sub_f32 v65, v65, v9
    v_sub_f32 v66, v66, v9
    v_sub_f32 v67, v67, v9
    v_sub_f32 v68, v68, v9
    v_sub_f32 v69, v69, v9
    v_sub_f32 v70, v70, v9
    v_sub_f32 v71, v71, v9
    v_sub_f32 v72, v72, v9
    v_sub_f32 v73, v73, v9
    v_sub_f32 v74, v74, v9
    v_sub_f32 v75, v75, v9
    v_sub_f32 v76, v76, v9
    v_sub_f32 v77, v77, v9
    v_sub_f32 v78, v78, v9
    v_sub_f32 v79, v79, v9
    v_sub_f32 v80, v80, v9
    v_sub_f32 v81, v81, v9
    v_sub_f32 v82, v82, v9
    v_sub_f32 v83, v83, v9
    v_sub_f32 v84, v84, v9
    v_sub_f32 v85, v85, v9
    v_sub_f32 v86, v86, v9
    v_sub_f32 v87, v87, v9
    v_sub_f32 v88, v88, v9
    v_sub_f32 v89, v89, v9
    v_sub_f32 v90, v90, v9
    v_sub_f32 v91, v91, v9
    v_sub_f32 v92, v92, v9
    v_sub_f32 v93, v93, v9
    v_sub_f32 v94, v94, v9
    v_sub_f32 v95, v95, v9
    v_sub_f32 v96, v96, v9
    v_sub_f32 v97, v97, v9
    v_sub_f32 v98, v98, v9
    v_sub_f32 v99, v99, v9
    v_sub_f32 v100, v100, v9
    v_sub_f32 v101, v101, v9
    v_sub_f32 v102, v102, v9
    v_sub_f32 v103, v103, v9
    v_sub_f32 v104, v104, v9
    v_sub_f32 v105, v105, v9
    v_sub_f32 v106, v106, v9
    v_sub_f32 v107, v107, v9
    v_sub_f32 v108, v108, v9
    v_sub_f32 v109, v109, v9
    v_sub_f32 v110, v110, v9
    v_sub_f32 v111, v111, v9
    v_mul_f32 v10, v48, v48
    v_fmac_f32 v10, v49, v49
    v_fmac_f32 v10, v50, v50
    v_fmac_f32 v10, v51, v51
    v_fmac_f32 v10, v52, v52
    v_fmac_f32 v10, v53, v53
    v_fmac_f32 v10, v54, v54
    v_fmac_f32 v10, v55, v55
    v_fmac_f32 v10, v56, v56
    v_fmac_f32 v10, v57, v57
    v_fmac_f32 v10, v58, v58
    v_fmac_f32 v10, v59, v59
    v_fmac_f32 v10, v60, v60
    v_fmac_f32 v10, v61, v61
    v_fmac_f32 v10, v62, v62
    v_fmac_f32 v10, v63, v63
    v_fmac_f32 v10, v64, v64
    v_fmac_f32 v10, v65, v65
    v_fmac_f32 v10, v66, v66
    v_fmac_f32 v10, v67, v67
    v_fmac_f32 v10, v68, v68
    v_fmac_f32 v10, v69, v69
    v_fmac_f32 v10, v70, v70
    v_fmac_f32 v10, v71, v71
    v_fmac_f32 v10, v72, v72
    v_fmac_f32 v10, v73, v73
    v_fmac_f32 v10, v74, v74
    v_fmac_f32 v10, v75, v75
    v_fmac_f32 v10, v76, v76
    v_fmac_f32 v10, v77, v77
    v_fmac_f32 v10, v78, v78
    v_fmac_f32 v10, v79, v79
    v_fmac_f32 v10, v80, v80
    v_fmac_f32 v10, v81, v81
    v_fmac_f32 v10, v82, v82
    v_fmac_f32 v10, v83, v83
    v_fmac_f32 v10, v84, v84
    v_fmac_f32 v10, v85, v85
    v_fmac_f32 v10, v86, v86
    v_fmac_f32 v10, v87, v87
    v_fmac_f32 v10, v88, v88
    v_fmac_f32 v10, v89, v89
    v_fmac_f32 v10, v90, v90
    v_fmac_f32 v10, v91, v91
    v_fmac_f32 v10, v92, v92
    v_fmac_f32 v10, v93, v93
    v_fmac_f32 v10, v94, v94
    v_fmac_f32 v10, v95, v95
    v_fmac_f32 v10, v96, v96
    v_fmac_f32 v10, v97, v97
    v_fmac_f32 v10, v98, v98
    v_fmac_f32 v10, v99, v99
    v_fmac_f32 v10, v100, v100
    v_fmac_f32 v10, v101, v101
    v_fmac_f32 v10, v102, v102
    v_fmac_f32 v10, v103, v103
    v_fmac_f32 v10, v104, v104
    v_fmac_f32 v10, v105, v105
    v_fmac_f32 v10, v106, v106
    v_fmac_f32 v10, v107, v107
    v_fmac_f32 v10, v108, v108
    v_fmac_f32 v10, v109, v109
    v_fmac_f32 v10, v110, v110
    v_fmac_f32 v10, v111, v111
    s_nop 1
    v_add_f32_dpp v10, v10, v10 quad_perm:[1,0,3,2] row_mask:0xf bank_mask:0xf
    s_nop 1
    v_add_f32_dpp v10, v10, v10 quad_perm:[2,3,0,1] row_mask:0xf bank_mask:0xf
    s_nop 1
    v_add_f32_dpp v10, v10, v10 row_half_mirror row_mask:0xf bank_mask:0xf
    v_mov_b32 v11, 0x3727c5ac
    v_fmac_f32 v11, 0x3b000000, v10
    v_rsq_f32 v11, v11
    s_nop 0
    v_mul_f32 v48, v48, v11
    v_mul_f32 v49, v49, v11
    v_mul_f32 v50, v50, v11
    v_mul_f32 v51, v51, v11
    v_mul_f32 v52, v52, v11
    v_mul_f32 v53, v53, v11
    v_mul_f32 v54, v54, v11
    v_mul_f32 v55, v55, v11
    v_mul_f32 v56, v56, v11
    v_mul_f32 v57, v57, v11
    v_mul_f32 v58, v58, v11
    v_mul_f32 v59, v59, v11
    v_mul_f32 v60, v60, v11
    v_mul_f32 v61, v61, v11
    v_mul_f32 v62, v62, v11
    v_mul_f32 v63, v63, v11
    v_mul_f32 v64, v64, v11
    v_mul_f32 v65, v65, v11
    v_mul_f32 v66, v66, v11
    v_mul_f32 v67, v67, v11
    v_mul_f32 v68, v68, v11
    v_mul_f32 v69, v69, v11
    v_mul_f32 v70, v70, v11
    v_mul_f32 v71, v71, v11
    v_mul_f32 v72, v72, v11
    v_mul_f32 v73, v73, v11
    v_mul_f32 v74, v74, v11
    v_mul_f32 v75, v75, v11
    v_mul_f32 v76, v76, v11
    v_mul_f32 v77, v77, v11
    v_mul_f32 v78, v78, v11
    v_mul_f32 v79, v79, v11
    v_mul_f32 v80, v80, v11
    v_mul_f32 v81, v81, v11
    v_mul_f32 v82, v82, v11
    v_mul_f32 v83, v83, v11
    v_mul_f32 v84, v84, v11
    v_mul_f32 v85, v85, v11
    v_mul_f32 v86, v86, v11
    v_mul_f32 v87, v87, v11
    v_mul_f32 v88, v88, v11
    v_mul_f32 v89, v89, v11
    v_mul_f32 v90, v90, v11
    v_mul_f32 v91, v91, v11
    v_mul_f32 v92, v92, v11
    v_mul_f32 v93, v93, v11
    v_mul_f32 v94, v94, v11
    v_mul_f32 v95, v95, v11
    v_mul_f32 v96, v96, v11
    v_mul_f32 v97, v97, v11
    v_mul_f32 v98, v98, v11
    v_mul_f32 v99, v99, v11
    v_mul_f32 v100, v100, v11
    v_mul_f32 v101, v101, v11
    v_mul_f32 v102, v102, v11
    v_mul_f32 v103, v103, v11
    v_mul_f32 v104, v104, v11
    v_mul_f32 v105, v105, v11
    v_mul_f32 v106, v106, v11
    v_mul_f32 v107, v107, v11
    v_mul_f32 v108, v108, v11
    v_mul_f32 v109, v109, v11
    v_mul_f32 v110, v110, v11
    v_mul_f32 v111, v111, v11
    v_cvt_pk_bf16_f32 v16, v48, v49
    v_cvt_pk_bf16_f32 v17, v50, v51
    v_cvt_pk_bf16_f32 v18, v52, v53
    v_cvt_pk_bf16_f32 v19, v54, v55
    v_cvt_pk_bf16_f32 v20, v56, v57
    v_cvt_pk_bf16_f32 v21, v58, v59
    v_cvt_pk_bf16_f32 v22, v60, v61
    v_cvt_pk_bf16_f32 v23, v62, v63
    v_cvt_pk_bf16_f32 v24, v64, v65
    v_cvt_pk_bf16_f32 v25, v66, v67
    v_cvt_pk_bf16_f32 v26, v68, v69
    v_cvt_pk_bf16_f32 v27, v70, v71
    v_cvt_pk_bf16_f32 v28, v72, v73
    v_cvt_pk_bf16_f32 v29, v74, v75
    v_cvt_pk_bf16_f32 v30, v76, v77
    v_cvt_pk_bf16_f32 v31, v78, v79
    v_cvt_pk_bf16_f32 v32, v80, v81
    v_cvt_pk_bf16_f32 v33, v82, v83
    v_cvt_pk_bf16_f32 v34, v84, v85
    v_cvt_pk_bf16_f32 v35, v86, v87
    v_cvt_pk_bf16_f32 v36, v88, v89
    v_cvt_pk_bf16_f32 v37, v90, v91
    v_cvt_pk_bf16_f32 v38, v92, v93
    v_cvt_pk_bf16_f32 v39, v94, v95
    v_cvt_pk_bf16_f32 v40, v96, v97
    v_cvt_pk_bf16_f32 v41, v98, v99
    v_cvt_pk_bf16_f32 v42, v100, v101
    v_cvt_pk_bf16_f32 v43, v102, v103
    v_cvt_pk_bf16_f32 v44, v104, v105
    v_cvt_pk_bf16_f32 v45, v106, v107
    v_cvt_pk_bf16_f32 v46, v108, v109
    v_cvt_pk_bf16_f32 v47, v110, v111
    v_mul_u32_u24 v9, 1040, v6
    v_lshl_add_u32 v9, v7, 4, v9
    ds_write_b128 v9, v[16:19] offset:0
    ds_write_b128 v9, v[20:23] offset:128
    ds_write_b128 v9, v[24:27] offset:256
    ds_write_b128 v9, v[28:31] offset:384
    ds_write_b128 v9, v[32:35] offset:512
    ds_write_b128 v9, v[36:39] offset:640
    ds_write_b128 v9, v[40:43] offset:768
    ds_write_b128 v9, v[44:47] offset:896
    s_waitcnt lgkmcnt(0)
    s_barrier
    v_mul_u32_u24 v9, 1040, v3
    v_lshl_add_u32 v9, v4, 4, v9
    s_lshl_b32 s27, s25, 5
    v_add_u32 v9, s27, v9
    v_mov_b32 v48, 0
    v_mov_b32 v49, 0
    v_mov_b32 v50, 0
    v_mov_b32 v51, 0
    v_mov_b32 v52, 0
    v_mov_b32 v53, 0
    v_mov_b32 v54, 0
    v_mov_b32 v55, 0
    v_mov_b32 v56, 0
    v_mov_b32 v57, 0
    v_mov_b32 v58, 0
    v_mov_b32 v59, 0
    v_mov_b32 v60, 0
    v_mov_b32 v61, 0
    v_mov_b32 v62, 0
    v_mov_b32 v63, 0
    v_mov_b32 v64, 0
    v_mov_b32 v65, 0
    v_mov_b32 v66, 0
    v_mov_b32 v67, 0
    v_mov_b32 v68, 0
    v_mov_b32 v69, 0
    v_mov_b32 v70, 0
    v_mov_b32 v71, 0
    v_mov_b32 v72, 0
    v_mov_b32 v73, 0
    v_mov_b32 v74, 0
    v_mov_b32 v75, 0
    v_mov_b32 v76, 0
    v_mov_b32 v77, 0
    v_mov_b32 v78, 0
    v_mov_b32 v79, 0
    v_mov_b32 v80, 0
    v_mov_b32 v81, 0
    v_mov_b32 v82, 0
    v_mov_b32 v83, 0
    v_mov_b32 v84, 0
    v_mov_b32 v85, 0
    v_mov_b32 v86, 0
    v_mov_b32 v87, 0
    v_mov_b32 v88, 0
    v_mov_b32 v89, 0
    v_mov_b32 v90, 0
    v_mov_b32 v91, 0
    v_mov_b32 v92, 0
    v_mov_b32 v93, 0
    v_mov_b32 v94, 0
    v_mov_b32 v95, 0
    v_mov_b32 v96, 0
    v_mov_b32 v97, 0
    v_mov_b32 v98, 0
    v_mov_b32 v99, 0
    v_mov_b32 v100, 0
    v_mov_b32 v101, 0
    v_mov_b32 v102, 0
    v_mov_b32 v103, 0
    v_mov_b32 v104, 0
    v_mov_b32 v105, 0
    v_mov_b32 v106, 0
    v_mov_b32 v107, 0
    v_mov_b32 v108, 0
    v_mov_b32 v109, 0
    v_mov_b32 v110, 0
    v_mov_b32 v111, 0
    ds_read_b128 v[40:43], v9 offset:0
    s_waitcnt vmcnt(32)
    v_perm_b32 v16, v130, v128, s40
    v_perm_b32 v17, v134, v132, s40
    v_perm_b32 v18, v138, v136, s40
    v_perm_b32 v19, v142, v140, s40
    v_perm_b32 v20, v130, v128, s41
    v_perm_b32 v21, v134, v132, s41
    v_perm_b32 v22, v138, v136, s41
    v_perm_b32 v23, v142, v140, s41
    v_perm_b32 v24, v131, v129, s40
    v_perm_b32 v25, v135, v133, s40
    v_perm_b32 v26, v139, v137, s40
    v_perm_b32 v27, v143, v141, s40
    v_perm_b32 v28, v131, v129, s41
    v_perm_b32 v29, v135, v133, s41
    v_perm_b32 v30, v139, v137, s41
    v_perm_b32 v31, v143, v141, s41
    s_waitcnt lgkmcnt(0)
    v_mfma_f32_32x32x16_bf16 v[48:63], v[16:19], v[40:43], v[48:63]
    v_mfma_f32_32x32x16_bf16 v[64:79], v[20:23], v[40:43], v[64:79]
    v_mfma_f32_32x32x16_bf16 v[80:95], v[24:27], v[40:43], v[80:95]
    v_mfma_f32_32x32x16_bf16 v[96:111], v[28:31], v[40:43], v[96:111]
    ds_read_b128 v[44:47], v9 offset:32
    v_perm_b32 v16, v146, v144, s40
    v_perm_b32 v17, v150, v148, s40
    v_perm_b32 v18, v154, v152, s40
    v_perm_b32 v19, v158, v156, s40
    v_perm_b32 v20, v146, v144, s41
    v_perm_b32 v21, v150, v148, s41
    v_perm_b32 v22, v154, v152, s41
    v_perm_b32 v23, v158, v156, s41
    v_perm_b32 v24, v147, v145, s40
    v_perm_b32 v25, v151, v149, s40
    v_perm_b32 v26, v155, v153, s40
    v_perm_b32 v27, v159, v157, s40
    v_perm_b32 v28, v147, v145, s41
    v_perm_b32 v29, v151, v149, s41
    v_perm_b32 v30, v155, v153, s41
    v_perm_b32 v31, v159, v157, s41
    s_waitcnt lgkmcnt(0)
    v_mfma_f32_32x32x16_bf16 v[48:63], v[16:19], v[44:47], v[48:63]
    v_mfma_f32_32x32x16_bf16 v[64:79], v[20:23], v[44:47], v[64:79]
    v_mfma_f32_32x32x16_bf16 v[80:95], v[24:27], v[44:47], v[80:95]
    v_mfma_f32_32x32x16_bf16 v[96:111], v[28:31], v[44:47], v[96:111]
    ds_read_b128 v[40:43], v9 offset:64
    v_perm_b32 v16, v162, v160, s40
    v_perm_b32 v17, v166, v164, s40
    v_perm_b32 v18, v170, v168, s40
    v_perm_b32 v19, v174, v172, s40
    v_perm_b32 v20, v162, v160, s41
    v_perm_b32 v21, v166, v164, s41
    v_perm_b32 v22, v170, v168, s41
    v_perm_b32 v23, v174, v172, s41
    v_perm_b32 v24, v163, v161, s40
    v_perm_b32 v25, v167, v165, s40
    v_perm_b32 v26, v171, v169, s40
    v_perm_b32 v27, v175, v173, s40
    v_perm_b32 v28, v163, v161, s41
    v_perm_b32 v29, v167, v165, s41
    v_perm_b32 v30, v171, v169, s41
    v_perm_b32 v31, v175, v173, s41
    s_waitcnt lgkmcnt(0)
    v_mfma_f32_32x32x16_bf16 v[48:63], v[16:19], v[40:43], v[48:63]
    v_mfma_f32_32x32x16_bf16 v[64:79], v[20:23], v[40:43], v[64:79]
    v_mfma_f32_32x32x16_bf16 v[80:95], v[24:27], v[40:43], v[80:95]
    v_mfma_f32_32x32x16_bf16 v[96:111], v[28:31], v[40:43], v[96:111]
    ds_read_b128 v[44:47], v9 offset:96
    v_perm_b32 v16, v178, v176, s40
    v_perm_b32 v17, v182, v180, s40
    v_perm_b32 v18, v186, v184, s40
    v_perm_b32 v19, v190, v188, s40
    v_perm_b32 v20, v178, v176, s41
    v_perm_b32 v21, v182, v180, s41
    v_perm_b32 v22, v186, v184, s41
    v_perm_b32 v23, v190, v188, s41
    v_perm_b32 v24, v179, v177, s40
    v_perm_b32 v25, v183, v181, s40
    v_perm_b32 v26, v187, v185, s40
    v_perm_b32 v27, v191, v189, s40
    v_perm_b32 v28, v179, v177, s41
    v_perm_b32 v29, v183, v181, s41
    v_perm_b32 v30, v187, v185, s41
    v_perm_b32 v31, v191, v189, s41
    s_waitcnt lgkmcnt(0)
    v_mfma_f32_32x32x16_bf16 v[48:63], v[16:19], v[44:47], v[48:63]
    v_mfma_f32_32x32x16_bf16 v[64:79], v[20:23], v[44:47], v[64:79]
    v_mfma_f32_32x32x16_bf16 v[80:95], v[24:27], v[44:47], v[80:95]
    v_mfma_f32_32x32x16_bf16 v[96:111], v[28:31], v[44:47], v[96:111]
    ds_read_b128 v[40:43], v9 offset:128
    s_waitcnt vmcnt(0)
    v_perm_b32 v16, v194, v192, s40
    v_perm_b32 v17, v198, v196, s40
    v_perm_b32 v18, v202, v200, s40
    v_perm_b32 v19, v206, v204, s40
    v_perm_b32 v20, v194, v192, s41
    v_perm_b32 v21, v198, v196, s41
    v_perm_b32 v22, v202, v200, s41
    v_perm_b32 v23, v206, v204, s41
    v_perm_b32 v24, v195, v193, s40
    v_perm_b32 v25, v199, v197, s40
    v_perm_b32 v26, v203, v201, s40
    v_perm_b32 v27, v207, v205, s40
    v_perm_b32 v28, v195, v193, s41
    v_perm_b32 v29, v199, v197, s41
    v_perm_b32 v30, v203, v201, s41
    v_perm_b32 v31, v207, v205, s41
    s_waitcnt lgkmcnt(0)
    v_mfma_f32_32x32x16_bf16 v[48:63], v[16:19], v[40:43], v[48:63]
    v_mfma_f32_32x32x16_bf16 v[64:79], v[20:23], v[40:43], v[64:79]
    v_mfma_f32_32x32x16_bf16 v[80:95], v[24:27], v[40:43], v[80:95]
    v_mfma_f32_32x32x16_bf16 v[96:111], v[28:31], v[40:43], v[96:111]
    ds_read_b128 v[44:47], v9 offset:160
    v_perm_b32 v16, v210, v208, s40
    v_perm_b32 v17, v214, v212, s40
    v_perm_b32 v18, v218, v216, s40
    v_perm_b32 v19, v222, v220, s40
    v_perm_b32 v20, v210, v208, s41
    v_perm_b32 v21, v214, v212, s41
    v_perm_b32 v22, v218, v216, s41
    v_perm_b32 v23, v222, v220, s41
    v_perm_b32 v24, v211, v209, s40
    v_perm_b32 v25, v215, v213, s40
    v_perm_b32 v26, v219, v217, s40
    v_perm_b32 v27, v223, v221, s40
    v_perm_b32 v28, v211, v209, s41
    v_perm_b32 v29, v215, v213, s41
    v_perm_b32 v30, v219, v217, s41
    v_perm_b32 v31, v223, v221, s41
    s_waitcnt lgkmcnt(0)
    v_mfma_f32_32x32x16_bf16 v[48:63], v[16:19], v[44:47], v[48:63]
    v_mfma_f32_32x32x16_bf16 v[64:79], v[20:23], v[44:47], v[64:79]
    v_mfma_f32_32x32x16_bf16 v[80:95], v[24:27], v[44:47], v[80:95]
    v_mfma_f32_32x32x16_bf16 v[96:111], v[28:31], v[44:47], v[96:111]
    ds_read_b128 v[40:43], v9 offset:192
    v_perm_b32 v16, v226, v224, s40
    v_perm_b32 v17, v230, v228, s40
    v_perm_b32 v18, v234, v232, s40
    v_perm_b32 v19, v238, v236, s40
    v_perm_b32 v20, v226, v224, s41
    v_perm_b32 v21, v230, v228, s41
    v_perm_b32 v22, v234, v232, s41
    v_perm_b32 v23, v238, v236, s41
    v_perm_b32 v24, v227, v225, s40
    v_perm_b32 v25, v231, v229, s40
    v_perm_b32 v26, v235, v233, s40
    v_perm_b32 v27, v239, v237, s40
    v_perm_b32 v28, v227, v225, s41
    v_perm_b32 v29, v231, v229, s41
    v_perm_b32 v30, v235, v233, s41
    v_perm_b32 v31, v239, v237, s41
    s_waitcnt lgkmcnt(0)
    v_mfma_f32_32x32x16_bf16 v[48:63], v[16:19], v[40:43], v[48:63]
    v_mfma_f32_32x32x16_bf16 v[64:79], v[20:23], v[40:43], v[64:79]
    v_mfma_f32_32x32x16_bf16 v[80:95], v[24:27], v[40:43], v[80:95]
    v_mfma_f32_32x32x16_bf16 v[96:111], v[28:31], v[40:43], v[96:111]
    ds_read_b128 v[44:47], v9 offset:224
    v_perm_b32 v16, v242, v240, s40
    v_perm_b32 v17, v246, v244, s40
    v_perm_b32 v18, v250, v248, s40
    v_perm_b32 v19, v254, v252, s40
    v_perm_b32 v20, v242, v240, s41
    v_perm_b32 v21, v246, v244, s41
    v_perm_b32 v22, v250, v248, s41
    v_perm_b32 v23, v254, v252, s41
    v_perm_b32 v24, v243, v241, s40
    v_perm_b32 v25, v247, v245, s40
    v_perm_b32 v26, v251, v249, s40
    v_perm_b32 v27, v255, v253, s40
    v_perm_b32 v28, v243, v241, s41
    v_perm_b32 v29, v247, v245, s41
    v_perm_b32 v30, v251, v249, s41
    v_perm_b32 v31, v255, v253, s41
    s_waitcnt lgkmcnt(0)
    v_mfma_f32_32x32x16_bf16 v[48:63], v[16:19], v[44:47], v[48:63]
    v_mfma_f32_32x32x16_bf16 v[64:79], v[20:23], v[44:47], v[64:79]
    v_mfma_f32_32x32x16_bf16 v[80:95], v[24:27], v[44:47], v[80:95]
    v_mfma_f32_32x32x16_bf16 v[96:111], v[28:31], v[44:47], v[96:111]
    s_nop 7
    s_nop 7
    s_waitcnt vmcnt(0)
    s_barrier
    v_lshlrev_b32 v9, 4, v2
    s_lshl_b32 s27, s5, 12
    v_add_u32 v10, s27, v9
    ds_write_b128 v10, v[48:51] offset:0
    ds_write_b128 v10, v[64:67] offset:1024
    ds_write_b128 v10, v[80:83] offset:2048
    ds_write_b128 v10, v[96:99] offset:3072
    ds_write_b128 v10, v[52:55] offset:16384
    ds_write_b128 v10, v[68:71] offset:17408
    ds_write_b128 v10, v[84:87] offset:18432
    ds_write_b128 v10, v[100:103] offset:19456
    ds_write_b128 v10, v[56:59] offset:32768
    ds_write_b128 v10, v[72:75] offset:33792
    ds_write_b128 v10, v[88:91] offset:34816
    ds_write_b128 v10, v[104:107] offset:35840
    ds_write_b128 v10, v[60:63] offset:49152
    ds_write_b128 v10, v[76:79] offset:50176
    ds_write_b128 v10, v[92:95] offset:51200
    ds_write_b128 v10, v[108:111] offset:52224
    s_waitcnt lgkmcnt(0)
    s_barrier
    s_lshl_b32 s27, s5, 14
    v_add_u32 v10, s27, v9
    ds_read_b128 v[128:131], v10 offset:0
    ds_read_b128 v[132:135], v10 offset:1024
    ds_read_b128 v[136:139], v10 offset:2048
    ds_read_b128 v[140:143], v10 offset:3072
    ds_read_b128 v[144:147], v10 offset:4096
    ds_read_b128 v[148:151], v10 offset:5120
    ds_read_b128 v[152:155], v10 offset:6144
    ds_read_b128 v[156:159], v10 offset:7168
    ds_read_b128 v[160:163], v10 offset:8192
    ds_read_b128 v[164:167], v10 offset:9216
    ds_read_b128 v[168:171], v10 offset:10240
    ds_read_b128 v[172:175], v10 offset:11264
    ds_read_b128 v[176:179], v10 offset:12288
    ds_read_b128 v[180:183], v10 offset:13312
    ds_read_b128 v[184:187], v10 offset:14336
    ds_read_b128 v[188:191], v10 offset:15360
    s_waitcnt lgkmcnt(0)
    v_add_f32 v48, v128, v144
    v_add_f32 v64, v160, v176
    v_add_f32 v49, v129, v145
    v_add_f32 v65, v161, v177
    v_add_f32 v50, v130, v146
    v_add_f32 v66, v162, v178
    v_add_f32 v51, v131, v147
    v_add_f32 v67, v163, v179
    v_add_f32 v52, v132, v148
    v_add_f32 v68, v164, v180
    v_add_f32 v53, v133, v149
    v_add_f32 v69, v165, v181
    v_add_f32 v54, v134, v150
    v_add_f32 v70, v166, v182
    v_add_f32 v55, v135, v151
    v_add_f32 v71, v167, v183
    v_add_f32 v56, v136, v152
    v_add_f32 v72, v168, v184
    v_add_f32 v57, v137, v153
    v_add_f32 v73, v169, v185
    v_add_f32 v58, v138, v154
    v_add_f32 v74, v170, v186
    v_add_f32 v59, v139, v155
    v_add_f32 v75, v171, v187
    v_add_f32 v60, v140, v156
    v_add_f32 v76, v172, v188
    v_add_f32 v61, v141, v157
    v_add_f32 v77, v173, v189
    v_add_f32 v62, v142, v158
    v_add_f32 v78, v174, v190
    v_add_f32 v63, v143, v159
    v_add_f32 v79, v175, v191
    v_add_f32 v48, v48, v64
    v_add_f32 v49, v49, v65
    v_add_f32 v50, v50, v66
    v_add_f32 v51, v51, v67
    v_add_f32 v52, v52, v68
    v_add_f32 v53, v53, v69
    v_add_f32 v54, v54, v70
    v_add_f32 v55, v55, v71
    v_add_f32 v56, v56, v72
    v_add_f32 v57, v57, v73
    v_add_f32 v58, v58, v74
    v_add_f32 v59, v59, v75
    v_add_f32 v60, v60, v76
    v_add_f32 v61, v61, v77
    v_add_f32 v62, v62, v78
    v_add_f32 v63, v63, v79
    v_add_u32 v8, s24, v3
    s_lshl_b32 s27, s4, 8
    s_lshl_b32 s28, s5, 6
    s_add_u32 s27, s27, s28
    v_lshlrev_b32 v9, 5, v4
    v_add_u32 v9, s27, v9
    s_cmp_lt_u32 s4, 4
    s_cselect_b32 s28, 0x3eb8aa3b, 1.0
    v_mul_f32 v48, s28, v48
    v_mul_f32 v49, s28, v49
    v_mul_f32 v50, s28, v50
    v_mul_f32 v51, s28, v51
    v_mul_f32 v52, s28, v52
    v_mul_f32 v53, s28, v53
    v_mul_f32 v54, s28, v54
    v_mul_f32 v55, s28, v55
    v_mul_f32 v56, s28, v56
    v_mul_f32 v57, s28, v57
    v_mul_f32 v58, s28, v58
    v_mul_f32 v59, s28, v59
    v_mul_f32 v60, s28, v60
    v_mul_f32 v61, s28, v61
    v_mul_f32 v62, s28, v62
    v_mul_f32 v63, s28, v63
    s_mov_b32 s28, s6
    s_mov_b32 s29, s7
    s_mov_b32 s30, 0x400000
    s_mov_b32 s31, 0x00020000
    s_lshl_b32 s27, s4, 19
    s_lshl_b32 s32, s5, 17
    s_add_u32 s27, s27, s32
    v_lshlrev_b32 v10, 16, v4
    v_lshl_add_u32 v10, v8, 5, v10
    v_add_u32 v10, s27, v10
    v_cvt_pk_bf16_f32 v16, v48, v52
    v_cvt_pk_bf16_f32 v17, v56, v60
    v_cvt_pk_bf16_f32 v18, v49, v53
    v_cvt_pk_bf16_f32 v19, v57, v61
    v_cvt_pk_bf16_f32 v20, v50, v54
    v_cvt_pk_bf16_f32 v21, v58, v62
    v_cvt_pk_bf16_f32 v22, v51, v55
    v_cvt_pk_bf16_f32 v23, v59, v63
    buffer_store_dwordx4 v[16:19], v10, s[28:31], 0 offen
    buffer_store_dwordx4 v[20:23], v10, s[28:31], 0 offen offset:16
L_end_k1qk:
    s_endpgm
k1v:
    s_and_b32 s3, s2, 63
    s_lshr_b32 s4, s2, 6
    s_cmp_ge_u32 s4, 4
    s_cbranch_scc1 L_end_k1v
    s_add_u32 s4, s4, 8
    s_load_dwordx2 s[6:7], s[0:1], 80
    s_load_dwordx2 s[8:9], s[0:1], 8
    s_load_dwordx2 s[10:11], s[0:1], 0
    s_load_dwordx2 s[12:13], s[0:1], 64
    v_lshrrev_b32 v1, 6, v0
    v_and_b32 v2, 63, v0
    v_and_b32 v3, 31, v2
    v_lshrrev_b32 v4, 5, v2
    v_readfirstlane_b32 s5, v1
    s_mov_b32 s40, 0x05040100
    s_mov_b32 s41, 0x07060302
    s_waitcnt lgkmcnt(0)
    s_mov_b32 s16, s10
    s_mov_b32 s17, s11
    s_mov_b32 s18, 0x200000
    s_mov_b32 s19, 0x00020000
    s_mov_b32 s20, s8
    s_mov_b32 s21, s9
    s_mov_b32 s22, 0x180000
    s_mov_b32 s23, 0x00020000
    s_lshl_b32 s24, s3, 5
    s_mul_i32 s25, s5, 8
    s_lshl_b32 s26, s4, 8
    s_mul_i32 s27, s25, 49152
    s_add_u32 s26, s26, s27
    v_mul_u32_u24 v5, 24576, v4
    v_lshl_add_u32 v5, v3, 3, v5
    v_lshrrev_b32 v6, 3, v0
    v_and_b32 v7, 7, v0
    v_add_u32 v8, s24, v6
    v_mul_u32_u24 v8, 1024, v8
    v_lshl_add_u32 v8, v7, 4, v8
    buffer_load_dwordx4 v[16:19], v8, s[16:19], 0 offen offset:0
    buffer_load_dwordx4 v[20:23], v8, s[16:19], 0 offen offset:128
    buffer_load_dwordx4 v[24:27], v8, s[16:19], 0 offen offset:256
    buffer_load_dwordx4 v[28:31], v8, s[16:19], 0 offen offset:384
    buffer_load_dwordx4 v[32:35], v8, s[16:19], 0 offen offset:512
    buffer_load_dwordx4 v[36:39], v8, s[16:19], 0 offen offset:640
    buffer_load_dwordx4 v[40:43], v8, s[16:19], 0 offen offset:768
    buffer_load_dwordx4 v[44:47], v8, s[16:19], 0 offen offset:896
    buffer_load_dwordx2 v[128:129], v5, s[20:23], s26 offen offset:0
    buffer_load_dwordx2 v[130:131], v5, s[20:23], s26 offen offset:3072
    s_add_u32 s28, s26, 0x1800
    buffer_load_dwordx2 v[132:133], v5, s[20:23], s28 offen
    s_add_u32 s28, s26, 0x2400
    buffer_load_dwordx2 v[134:135], v5, s[20:23], s28 offen
    s_add_u32 s28, s26, 0x3000
    buffer_load_dwordx2 v[136:137], v5, s[20:23], s28 offen
    s_add_u32 s28, s26, 0x3c00
    buffer_load_dwordx2 v[138:139], v5, s[20:23], s28 offen
    s_add_u32 s28, s26, 0x4800
    buffer_load_dwordx2 v[140:141], v5, s[20:23], s28 offen
    s_add_u32 s28, s26, 0x5400
    buffer_load_dwordx2 v[142:143], v5, s[20:23], s28 offen
    s_add_u32 s28, s26, 0xc000
    buffer_load_dwordx2 v[144:145], v5, s[20:23], s28 offen
    s_add_u32 s28, s26, 0xcc00
    buffer_load_dwordx2 v[146:147], v5, s[20:23], s28 offen
    s_add_u32 s28, s26, 0xd800
    buffer_load_dwordx2 v[148:149], v5, s[20:23], s28 offen
    s_add_u32 s28, s26, 0xe400
    buffer_load_dwordx2 v[150:151], v5, s[20:23], s28 offen
    s_add_u32 s28, s26, 0xf000
    buffer_load_dwordx2 v[152:153], v5, s[20:23], s28 offen
    s_add_u32 s28, s26, 0xfc00
    buffer_load_dwordx2 v[154:155], v5, s[20:23], s28 offen
    s_add_u32 s28, s26, 0x10800
    buffer_load_dwordx2 v[156:157], v5, s[20:23], s28 offen
    s_add_u32 s28, s26, 0x11400
    buffer_load_dwordx2 v[158:159], v5, s[20:23], s28 offen
    s_add_u32 s28, s26, 0x18000
    buffer_load_dwordx2 v[160:161], v5, s[20:23], s28 offen
    s_add_u32 s28, s26, 0x18c00
    buffer_load_dwordx2 v[162:163], v5, s[20:23], s28 offen
    s_add_u32 s28, s26, 0x19800
    buffer_load_dwordx2 v[164:165], v5, s[20:23], s28 offen
    s_add_u32 s28, s26, 0x1a400
    buffer_load_dwordx2 v[166:167], v5, s[20:23], s28 offen
    s_add_u32 s28, s26, 0x1b000
    buffer_load_dwordx2 v[168:169], v5, s[20:23], s28 offen
    s_add_u32 s28, s26, 0x1bc00
    buffer_load_dwordx2 v[170:171], v5, s[20:23], s28 offen
    s_add_u32 s28, s26, 0x1c800
    buffer_load_dwordx2 v[172:173], v5, s[20:23], s28 offen
    s_add_u32 s28, s26, 0x1d400
    buffer_load_dwordx2 v[174:175], v5, s[20:23], s28 offen
    s_add_u32 s28, s26, 0x24000
    buffer_load_dwordx2 v[176:177], v5, s[20:23], s28 offen
    s_add_u32 s28, s26, 0x24c00
    buffer_load_dwordx2 v[178:179], v5, s[20:23], s28 offen
    s_add_u32 s28, s26, 0x25800
    buffer_load_dwordx2 v[180:181], v5, s[20:23], s28 offen
    s_add_u32 s28, s26, 0x26400
    buffer_load_dwordx2 v[182:183], v5, s[20:23], s28 offen
    s_add_u32 s28, s26, 0x27000
    buffer_load_dwordx2 v[184:185], v5, s[20:23], s28 offen
    s_add_u32 s28, s26, 0x27c00
    buffer_load_dwordx2 v[186:187], v5, s[20:23], s28 offen
    s_add_u32 s28, s26, 0x28800
    buffer_load_dwordx2 v[188:189], v5, s[20:23], s28 offen
    s_add_u32 s28, s26, 0x29400
    buffer_load_dwordx2 v[190:191], v5, s[20:23], s28 offen
    s_waitcnt vmcnt(32)
    s_add_u32 s28, s26, 0x30000
    buffer_load_dwordx2 v[192:193], v5, s[20:23], s28 offen
    s_add_u32 s28, s26, 0x30c00
    buffer_load_dwordx2 v[194:195], v5, s[20:23], s28 offen
    s_add_u32 s28, s26, 0x31800
    buffer_load_dwordx2 v[196:197], v5, s[20:23], s28 offen
    s_add_u32 s28, s26, 0x32400
    buffer_load_dwordx2 v[198:199], v5, s[20:23], s28 offen
    s_add_u32 s28, s26, 0x33000
    buffer_load_dwordx2 v[200:201], v5, s[20:23], s28 offen
    s_add_u32 s28, s26, 0x33c00
    buffer_load_dwordx2 v[202:203], v5, s[20:23], s28 offen
    s_add_u32 s28, s26, 0x34800
    buffer_load_dwordx2 v[204:205], v5, s[20:23], s28 offen
    s_add_u32 s28, s26, 0x35400
    buffer_load_dwordx2 v[206:207], v5, s[20:23], s28 offen
    s_add_u32 s28, s26, 0x3c000
    buffer_load_dwordx2 v[208:209], v5, s[20:23], s28 offen
    s_add_u32 s28, s26, 0x3cc00
    buffer_load_dwordx2 v[210:211], v5, s[20:23], s28 offen
    s_add_u32 s28, s26, 0x3d800
    buffer_load_dwordx2 v[212:213], v5, s[20:23], s28 offen
    s_add_u32 s28, s26, 0x3e400
    buffer_load_dwordx2 v[214:215], v5, s[20:23], s28 offen
    s_add_u32 s28, s26, 0x3f000
    buffer_load_dwordx2 v[216:217], v5, s[20:23], s28 offen
    s_add_u32 s28, s26, 0x3fc00
    buffer_load_dwordx2 v[218:219], v5, s[20:23], s28 offen
    s_add_u32 s28, s26, 0x40800
    buffer_load_dwordx2 v[220:221], v5, s[20:23], s28 offen
    s_add_u32 s28, s26, 0x41400
    buffer_load_dwordx2 v[222:223], v5, s[20:23], s28 offen
    s_add_u32 s28, s26, 0x48000
    buffer_load_dwordx2 v[224:225], v5, s[20:23], s28 offen
    s_add_u32 s28, s26, 0x48c00
    buffer_load_dwordx2 v[226:227], v5, s[20:23], s28 offen
    s_add_u32 s28, s26, 0x49800
    buffer_load_dwordx2 v[228:229], v5, s[20:23], s28 offen
    s_add_u32 s28, s26, 0x4a400
    buffer_load_dwordx2 v[230:231], v5, s[20:23], s28 offen
    s_add_u32 s28, s26, 0x4b000
    buffer_load_dwordx2 v[232:233], v5, s[20:23], s28 offen
    s_add_u32 s28, s26, 0x4bc00
    buffer_load_dwordx2 v[234:235], v5, s[20:23], s28 offen
    s_add_u32 s28, s26, 0x4c800
    buffer_load_dwordx2 v[236:237], v5, s[20:23], s28 offen
    s_add_u32 s28, s26, 0x4d400
    buffer_load_dwordx2 v[238:239], v5, s[20:23], s28 offen
    s_add_u32 s28, s26, 0x54000
    buffer_load_dwordx2 v[240:241], v5, s[20:23], s28 offen
    s_add_u32 s28, s26, 0x54c00
    buffer_load_dwordx2 v[242:243], v5, s[20:23], s28 offen
    s_add_u32 s28, s26, 0x55800
    buffer_load_dwordx2 v[244:245], v5, s[20:23], s28 offen
    s_add_u32 s28, s26, 0x56400
    buffer_load_dwordx2 v[246:247], v5, s[20:23], s28 offen
    s_add_u32 s28, s26, 0x57000
    buffer_load_dwordx2 v[248:249], v5, s[20:23], s28 offen
    s_add_u32 s28, s26, 0x57c00
    buffer_load_dwordx2 v[250:251], v5, s[20:23], s28 offen
    s_add_u32 s28, s26, 0x58800
    buffer_load_dwordx2 v[252:253], v5, s[20:23], s28 offen
    s_add_u32 s28, s26, 0x59400
    buffer_load_dwordx2 v[254:255], v5, s[20:23], s28 offen
    v_lshlrev_b32 v48, 16, v16
    v_and_b32 v49, 0xffff0000, v16
    v_lshlrev_b32 v50, 16, v17
    v_and_b32 v51, 0xffff0000, v17
    v_lshlrev_b32 v52, 16, v18
    v_and_b32 v53, 0xffff0000, v18
    v_lshlrev_b32 v54, 16, v19
    v_and_b32 v55, 0xffff0000, v19
    v_lshlrev_b32 v56, 16, v20
    v_and_b32 v57, 0xffff0000, v20
    v_lshlrev_b32 v58, 16, v21
    v_and_b32 v59, 0xffff0000, v21
    v_lshlrev_b32 v60, 16, v22
    v_and_b32 v61, 0xffff0000, v22
    v_lshlrev_b32 v62, 16, v23
    v_and_b32 v63, 0xffff0000, v23
    v_lshlrev_b32 v64, 16, v24
    v_and_b32 v65, 0xffff0000, v24
    v_lshlrev_b32 v66, 16, v25
    v_and_b32 v67, 0xffff0000, v25
    v_lshlrev_b32 v68, 16, v26
    v_and_b32 v69, 0xffff0000, v26
    v_lshlrev_b32 v70, 16, v27
    v_and_b32 v71, 0xffff0000, v27
    v_lshlrev_b32 v72, 16, v28
    v_and_b32 v73, 0xffff0000, v28
    v_lshlrev_b32 v74, 16, v29
    v_and_b32 v75, 0xffff0000, v29
    v_lshlrev_b32 v76, 16, v30
    v_and_b32 v77, 0xffff0000, v30
    v_lshlrev_b32 v78, 16, v31
    v_and_b32 v79, 0xffff0000, v31
    v_lshlrev_b32 v80, 16, v32
    v_and_b32 v81, 0xffff0000, v32
    v_lshlrev_b32 v82, 16, v33
    v_and_b32 v83, 0xffff0000, v33
    v_lshlrev_b32 v84, 16, v34
    v_and_b32 v85, 0xffff0000, v34
    v_lshlrev_b32 v86, 16, v35
    v_and_b32 v87, 0xffff0000, v35
    v_lshlrev_b32 v88, 16, v36
    v_and_b32 v89, 0xffff0000, v36
    v_lshlrev_b32 v90, 16, v37
    v_and_b32 v91, 0xffff0000, v37
    v_lshlrev_b32 v92, 16, v38
    v_and_b32 v93, 0xffff0000, v38
    v_lshlrev_b32 v94, 16, v39
    v_and_b32 v95, 0xffff0000, v39
    v_lshlrev_b32 v96, 16, v40
    v_and_b32 v97, 0xffff0000, v40
    v_lshlrev_b32 v98, 16, v41
    v_and_b32 v99, 0xffff0000, v41
    v_lshlrev_b32 v100, 16, v42
    v_and_b32 v101, 0xffff0000, v42
    v_lshlrev_b32 v102, 16, v43
    v_and_b32 v103, 0xffff0000, v43
    v_lshlrev_b32 v104, 16, v44
    v_and_b32 v105, 0xffff0000, v44
    v_lshlrev_b32 v106, 16, v45
    v_and_b32 v107, 0xffff0000, v45
    v_lshlrev_b32 v108, 16, v46
    v_and_b32 v109, 0xffff0000, v46
    v_lshlrev_b32 v110, 16, v47
    v_and_b32 v111, 0xffff0000, v47
    v_add_f32 v9, v48, v49
    v_add_f32 v9, v9, v50
    v_add_f32 v9, v9, v51
    v_add_f32 v9, v9, v52
    v_add_f32 v9, v9, v53
    v_add_f32 v9, v9, v54
    v_add_f32 v9, v9, v55
    v_add_f32 v9, v9, v56
    v_add_f32 v9, v9, v57
    v_add_f32 v9, v9, v58
    v_add_f32 v9, v9, v59
    v_add_f32 v9, v9, v60
    v_add_f32 v9, v9, v61
    v_add_f32 v9, v9, v62
    v_add_f32 v9, v9, v63
    v_add_f32 v9, v9, v64
    v_add_f32 v9, v9, v65
    v_add_f32 v9, v9, v66
    v_add_f32 v9, v9, v67
    v_add_f32 v9, v9, v68
    v_add_f32 v9, v9, v69
    v_add_f32 v9, v9, v70
    v_add_f32 v9, v9, v71
    v_add_f32 v9, v9, v72
    v_add_f32 v9, v9, v73
    v_add_f32 v9, v9, v74
    v_add_f32 v9, v9, v75
    v_add_f32 v9, v9, v76
    v_add_f32 v9, v9, v77
    v_add_f32 v9, v9, v78
    v_add_f32 v9, v9, v79
    v_add_f32 v9, v9, v80
    v_add_f32 v9, v9, v81
    v_add_f32 v9, v9, v82
    v_add_f32 v9, v9, v83
    v_add_f32 v9, v9, v84
    v_add_f32 v9, v9, v85
    v_add_f32 v9, v9, v86
    v_add_f32 v9, v9, v87
    v_add_f32 v9, v9, v88
    v_add_f32 v9, v9, v89
    v_add_f32 v9, v9, v90
    v_add_f32 v9, v9, v91
    v_add_f32 v9, v9, v92
    v_add_f32 v9, v9, v93
    v_add_f32 v9, v9, v94
    v_add_f32 v9, v9, v95
    v_add_f32 v9, v9, v96
    v_add_f32 v9, v9, v97
    v_add_f32 v9, v9, v98
    v_add_f32 v9, v9, v99
    v_add_f32 v9, v9, v100
    v_add_f32 v9, v9, v101
    v_add_f32 v9, v9, v102
    v_add_f32 v9, v9, v103
    v_add_f32 v9, v9, v104
    v_add_f32 v9, v9, v105
    v_add_f32 v9, v9, v106
    v_add_f32 v9, v9, v107
    v_add_f32 v9, v9, v108
    v_add_f32 v9, v9, v109
    v_add_f32 v9, v9, v110
    v_add_f32 v9, v9, v111
    s_nop 1
    v_add_f32_dpp v9, v9, v9 quad_perm:[1,0,3,2] row_mask:0xf bank_mask:0xf
    s_nop 1
    v_add_f32_dpp v9, v9, v9 quad_perm:[2,3,0,1] row_mask:0xf bank_mask:0xf
    s_nop 1
    v_add_f32_dpp v9, v9, v9 row_half_mirror row_mask:0xf bank_mask:0xf
    v_mul_f32 v9, 0x3b000000, v9
    v_sub_f32 v48, v48, v9
    v_sub_f32 v49, v49, v9
    v_sub_f32 v50, v50, v9
    v_sub_f32 v51, v51, v9
    v_sub_f32 v52, v52, v9
    v_sub_f32 v53, v53, v9
    v_sub_f32 v54, v54, v9
    v_sub_f32 v55, v55, v9
    v_sub_f32 v56, v56, v9
    v_sub_f32 v57, v57, v9
    v_sub_f32 v58, v58, v9
    v_sub_f32 v59, v59, v9
    v_sub_f32 v60, v60, v9
    v_sub_f32 v61, v61, v9
    v_sub_f32 v62, v62, v9
    v_sub_f32 v63, v63, v9
    v_sub_f32 v64, v64, v9
    v_sub_f32 v65, v65, v9
    v_sub_f32 v66, v66, v9
    v_sub_f32 v67, v67, v9
    v_sub_f32 v68, v68, v9
    v_sub_f32 v69, v69, v9
    v_sub_f32 v70, v70, v9
    v_sub_f32 v71, v71, v9
    v_sub_f32 v72, v72, v9
    v_sub_f32 v73, v73, v9
    v_sub_f32 v74, v74, v9
    v_sub_f32 v75, v75, v9
    v_sub_f32 v76, v76, v9
    v_sub_f32 v77, v77, v9
    v_sub_f32 v78, v78, v9
    v_sub_f32 v79, v79, v9
    v_sub_f32 v80, v80, v9
    v_sub_f32 v81, v81, v9
    v_sub_f32 v82, v82, v9
    v_sub_f32 v83, v83, v9
    v_sub_f32 v84, v84, v9
    v_sub_f32 v85, v85, v9
    v_sub_f32 v86, v86, v9
    v_sub_f32 v87, v87, v9
    v_sub_f32 v88, v88, v9
    v_sub_f32 v89, v89, v9
    v_sub_f32 v90, v90, v9
    v_sub_f32 v91, v91, v9
    v_sub_f32 v92, v92, v9
    v_sub_f32 v93, v93, v9
    v_sub_f32 v94, v94, v9
    v_sub_f32 v95, v95, v9
    v_sub_f32 v96, v96, v9
    v_sub_f32 v97, v97, v9
    v_sub_f32 v98, v98, v9
    v_sub_f32 v99, v99, v9
    v_sub_f32 v100, v100, v9
    v_sub_f32 v101, v101, v9
    v_sub_f32 v102, v102, v9
    v_sub_f32 v103, v103, v9
    v_sub_f32 v104, v104, v9
    v_sub_f32 v105, v105, v9
    v_sub_f32 v106, v106, v9
    v_sub_f32 v107, v107, v9
    v_sub_f32 v108, v108, v9
    v_sub_f32 v109, v109, v9
    v_sub_f32 v110, v110, v9
    v_sub_f32 v111, v111, v9
    v_mul_f32 v10, v48, v48
    v_fmac_f32 v10, v49, v49
    v_fmac_f32 v10, v50, v50
    v_fmac_f32 v10, v51, v51
    v_fmac_f32 v10, v52, v52
    v_fmac_f32 v10, v53, v53
    v_fmac_f32 v10, v54, v54
    v_fmac_f32 v10, v55, v55
    v_fmac_f32 v10, v56, v56
    v_fmac_f32 v10, v57, v57
    v_fmac_f32 v10, v58, v58
    v_fmac_f32 v10, v59, v59
    v_fmac_f32 v10, v60, v60
    v_fmac_f32 v10, v61, v61
    v_fmac_f32 v10, v62, v62
    v_fmac_f32 v10, v63, v63
    v_fmac_f32 v10, v64, v64
    v_fmac_f32 v10, v65, v65
    v_fmac_f32 v10, v66, v66
    v_fmac_f32 v10, v67, v67
    v_fmac_f32 v10, v68, v68
    v_fmac_f32 v10, v69, v69
    v_fmac_f32 v10, v70, v70
    v_fmac_f32 v10, v71, v71
    v_fmac_f32 v10, v72, v72
    v_fmac_f32 v10, v73, v73
    v_fmac_f32 v10, v74, v74
    v_fmac_f32 v10, v75, v75
    v_fmac_f32 v10, v76, v76
    v_fmac_f32 v10, v77, v77
    v_fmac_f32 v10, v78, v78
    v_fmac_f32 v10, v79, v79
    v_fmac_f32 v10, v80, v80
    v_fmac_f32 v10, v81, v81
    v_fmac_f32 v10, v82, v82
    v_fmac_f32 v10, v83, v83
    v_fmac_f32 v10, v84, v84
    v_fmac_f32 v10, v85, v85
    v_fmac_f32 v10, v86, v86
    v_fmac_f32 v10, v87, v87
    v_fmac_f32 v10, v88, v88
    v_fmac_f32 v10, v89, v89
    v_fmac_f32 v10, v90, v90
    v_fmac_f32 v10, v91, v91
    v_fmac_f32 v10, v92, v92
    v_fmac_f32 v10, v93, v93
    v_fmac_f32 v10, v94, v94
    v_fmac_f32 v10, v95, v95
    v_fmac_f32 v10, v96, v96
    v_fmac_f32 v10, v97, v97
    v_fmac_f32 v10, v98, v98
    v_fmac_f32 v10, v99, v99
    v_fmac_f32 v10, v100, v100
    v_fmac_f32 v10, v101, v101
    v_fmac_f32 v10, v102, v102
    v_fmac_f32 v10, v103, v103
    v_fmac_f32 v10, v104, v104
    v_fmac_f32 v10, v105, v105
    v_fmac_f32 v10, v106, v106
    v_fmac_f32 v10, v107, v107
    v_fmac_f32 v10, v108, v108
    v_fmac_f32 v10, v109, v109
    v_fmac_f32 v10, v110, v110
    v_fmac_f32 v10, v111, v111
    s_nop 1
    v_add_f32_dpp v10, v10, v10 quad_perm:[1,0,3,2] row_mask:0xf bank_mask:0xf
    s_nop 1
    v_add_f32_dpp v10, v10, v10 quad_perm:[2,3,0,1] row_mask:0xf bank_mask:0xf
    s_nop 1
    v_add_f32_dpp v10, v10, v10 row_half_mirror row_mask:0xf bank_mask:0xf
    v_mov_b32 v11, 0x3727c5ac
    v_fmac_f32 v11, 0x3b000000, v10
    v_rsq_f32 v11, v11
    s_nop 0
    v_mul_f32 v48, v48, v11
    v_mul_f32 v49, v49, v11
    v_mul_f32 v50, v50, v11
    v_mul_f32 v51, v51, v11
    v_mul_f32 v52, v52, v11
    v_mul_f32 v53, v53, v11
    v_mul_f32 v54, v54, v11
    v_mul_f32 v55, v55, v11
    v_mul_f32 v56, v56, v11
    v_mul_f32 v57, v57, v11
    v_mul_f32 v58, v58, v11
    v_mul_f32 v59, v59, v11
    v_mul_f32 v60, v60, v11
    v_mul_f32 v61, v61, v11
    v_mul_f32 v62, v62, v11
    v_mul_f32 v63, v63, v11
    v_mul_f32 v64, v64, v11
    v_mul_f32 v65, v65, v11
    v_mul_f32 v66, v66, v11
    v_mul_f32 v67, v67, v11
    v_mul_f32 v68, v68, v11
    v_mul_f32 v69, v69, v11
    v_mul_f32 v70, v70, v11
    v_mul_f32 v71, v71, v11
    v_mul_f32 v72, v72, v11
    v_mul_f32 v73, v73, v11
    v_mul_f32 v74, v74, v11
    v_mul_f32 v75, v75, v11
    v_mul_f32 v76, v76, v11
    v_mul_f32 v77, v77, v11
    v_mul_f32 v78, v78, v11
    v_mul_f32 v79, v79, v11
    v_mul_f32 v80, v80, v11
    v_mul_f32 v81, v81, v11
    v_mul_f32 v82, v82, v11
    v_mul_f32 v83, v83, v11
    v_mul_f32 v84, v84, v11
    v_mul_f32 v85, v85, v11
    v_mul_f32 v86, v86, v11
    v_mul_f32 v87, v87, v11
    v_mul_f32 v88, v88, v11
    v_mul_f32 v89, v89, v11
    v_mul_f32 v90, v90, v11
    v_mul_f32 v91, v91, v11
    v_mul_f32 v92, v92, v11
    v_mul_f32 v93, v93, v11
    v_mul_f32 v94, v94, v11
    v_mul_f32 v95, v95, v11
    v_mul_f32 v96, v96, v11
    v_mul_f32 v97, v97, v11
    v_mul_f32 v98, v98, v11
    v_mul_f32 v99, v99, v11
    v_mul_f32 v100, v100, v11
    v_mul_f32 v101, v101, v11
    v_mul_f32 v102, v102, v11
    v_mul_f32 v103, v103, v11
    v_mul_f32 v104, v104, v11
    v_mul_f32 v105, v105, v11
    v_mul_f32 v106, v106, v11
    v_mul_f32 v107, v107, v11
    v_mul_f32 v108, v108, v11
    v_mul_f32 v109, v109, v11
    v_mul_f32 v110, v110, v11
    v_mul_f32 v111, v111, v11
    v_cvt_pk_bf16_f32 v16, v48, v49
    v_cvt_pk_bf16_f32 v17, v50, v51
    v_cvt_pk_bf16_f32 v18, v52, v53
    v_cvt_pk_bf16_f32 v19, v54, v55
    v_cvt_pk_bf16_f32 v20, v56, v57
    v_cvt_pk_bf16_f32 v21, v58, v59
    v_cvt_pk_bf16_f32 v22, v60, v61
    v_cvt_pk_bf16_f32 v23, v62, v63
    v_cvt_pk_bf16_f32 v24, v64, v65
    v_cvt_pk_bf16_f32 v25, v66, v67
    v_cvt_pk_bf16_f32 v26, v68, v69
    v_cvt_pk_bf16_f32 v27, v70, v71
    v_cvt_pk_bf16_f32 v28, v72, v73
    v_cvt_pk_bf16_f32 v29, v74, v75
    v_cvt_pk_bf16_f32 v30, v76, v77
    v_cvt_pk_bf16_f32 v31, v78, v79
    v_cvt_pk_bf16_f32 v32, v80, v81
    v_cvt_pk_bf16_f32 v33, v82, v83
    v_cvt_pk_bf16_f32 v34, v84, v85
    v_cvt_pk_bf16_f32 v35, v86, v87
    v_cvt_pk_bf16_f32 v36, v88, v89
    v_cvt_pk_bf16_f32 v37, v90, v91
    v_cvt_pk_bf16_f32 v38, v92, v93
    v_cvt_pk_bf16_f32 v39, v94, v95
    v_cvt_pk_bf16_f32 v40, v96, v97
    v_cvt_pk_bf16_f32 v41, v98, v99
    v_cvt_pk_bf16_f32 v42, v100, v101
    v_cvt_pk_bf16_f32 v43, v102, v103
    v_cvt_pk_bf16_f32 v44, v104, v105
    v_cvt_pk_bf16_f32 v45, v106, v107
    v_cvt_pk_bf16_f32 v46, v108, v109
    v_cvt_pk_bf16_f32 v47, v110, v111
    v_mul_u32_u24 v9, 1040, v6
    v_lshl_add_u32 v9, v7, 4, v9
    ds_write_b128 v9, v[16:19] offset:0
    ds_write_b128 v9, v[20:23] offset:128
    ds_write_b128 v9, v[24:27] offset:256
    ds_write_b128 v9, v[28:31] offset:384
    ds_write_b128 v9, v[32:35] offset:512
    ds_write_b128 v9, v[36:39] offset:640
    ds_write_b128 v9, v[40:43] offset:768
    ds_write_b128 v9, v[44:47] offset:896
    s_waitcnt lgkmcnt(0)
    s_barrier
    v_mul_u32_u24 v9, 1040, v3
    v_lshl_add_u32 v9, v4, 4, v9
    s_lshl_b32 s27, s25, 5
    v_add_u32 v9, s27, v9
    v_mov_b32 v48, 0
    v_mov_b32 v49, 0
    v_mov_b32 v50, 0
    v_mov_b32 v51, 0
    v_mov_b32 v52, 0
    v_mov_b32 v53, 0
    v_mov_b32 v54, 0
    v_mov_b32 v55, 0
    v_mov_b32 v56, 0
    v_mov_b32 v57, 0
    v_mov_b32 v58, 0
    v_mov_b32 v59, 0
    v_mov_b32 v60, 0
    v_mov_b32 v61, 0
    v_mov_b32 v62, 0
    v_mov_b32 v63, 0
    v_mov_b32 v64, 0
    v_mov_b32 v65, 0
    v_mov_b32 v66, 0
    v_mov_b32 v67, 0
    v_mov_b32 v68, 0
    v_mov_b32 v69, 0
    v_mov_b32 v70, 0
    v_mov_b32 v71, 0
    v_mov_b32 v72, 0
    v_mov_b32 v73, 0
    v_mov_b32 v74, 0
    v_mov_b32 v75, 0
    v_mov_b32 v76, 0
    v_mov_b32 v77, 0
    v_mov_b32 v78, 0
    v_mov_b32 v79, 0
    v_mov_b32 v80, 0
    v_mov_b32 v81, 0
    v_mov_b32 v82, 0
    v_mov_b32 v83, 0
    v_mov_b32 v84, 0
    v_mov_b32 v85, 0
    v_mov_b32 v86, 0
    v_mov_b32 v87, 0
    v_mov_b32 v88, 0
    v_mov_b32 v89, 0
    v_mov_b32 v90, 0
    v_mov_b32 v91, 0
    v_mov_b32 v92, 0
    v_mov_b32 v93, 0
    v_mov_b32 v94, 0
    v_mov_b32 v95, 0
    v_mov_b32 v96, 0
    v_mov_b32 v97, 0
    v_mov_b32 v98, 0
    v_mov_b32 v99, 0
    v_mov_b32 v100, 0
    v_mov_b32 v101, 0
    v_mov_b32 v102, 0
    v_mov_b32 v103, 0
    v_mov_b32 v104, 0
    v_mov_b32 v105, 0
    v_mov_b32 v106, 0
    v_mov_b32 v107, 0
    v_mov_b32 v108, 0
    v_mov_b32 v109, 0
    v_mov_b32 v110, 0
    v_mov_b32 v111, 0
    ds_read_b128 v[40:43], v9 offset:0
    s_waitcnt vmcnt(32)
    v_perm_b32 v16, v130, v128, s40
    v_perm_b32 v17, v134, v132, s40
    v_perm_b32 v18, v138, v136, s40
    v_perm_b32 v19, v142, v140, s40
    v_perm_b32 v20, v130, v128, s41
    v_perm_b32 v21, v134, v132, s41
    v_perm_b32 v22, v138, v136, s41
    v_perm_b32 v23, v142, v140, s41
    v_perm_b32 v24, v131, v129, s40
    v_perm_b32 v25, v135, v133, s40
    v_perm_b32 v26, v139, v137, s40
    v_perm_b32 v27, v143, v141, s40
    v_perm_b32 v28, v131, v129, s41
    v_perm_b32 v29, v135, v133, s41
    v_perm_b32 v30, v139, v137, s41
    v_perm_b32 v31, v143, v141, s41
    s_waitcnt lgkmcnt(0)
    v_mfma_f32_32x32x16_bf16 v[48:63], v[40:43], v[16:19], v[48:63]
    v_mfma_f32_32x32x16_bf16 v[64:79], v[40:43], v[20:23], v[64:79]
    v_mfma_f32_32x32x16_bf16 v[80:95], v[40:43], v[24:27], v[80:95]
    v_mfma_f32_32x32x16_bf16 v[96:111], v[40:43], v[28:31], v[96:111]
    ds_read_b128 v[44:47], v9 offset:32
    v_perm_b32 v16, v146, v144, s40
    v_perm_b32 v17, v150, v148, s40
    v_perm_b32 v18, v154, v152, s40
    v_perm_b32 v19, v158, v156, s40
    v_perm_b32 v20, v146, v144, s41
    v_perm_b32 v21, v150, v148, s41
    v_perm_b32 v22, v154, v152, s41
    v_perm_b32 v23, v158, v156, s41
    v_perm_b32 v24, v147, v145, s40
    v_perm_b32 v25, v151, v149, s40
    v_perm_b32 v26, v155, v153, s40
    v_perm_b32 v27, v159, v157, s40
    v_perm_b32 v28, v147, v145, s41
    v_perm_b32 v29, v151, v149, s41
    v_perm_b32 v30, v155, v153, s41
    v_perm_b32 v31, v159, v157, s41
    s_waitcnt lgkmcnt(0)
    v_mfma_f32_32x32x16_bf16 v[48:63], v[44:47], v[16:19], v[48:63]
    v_mfma_f32_32x32x16_bf16 v[64:79], v[44:47], v[20:23], v[64:79]
    v_mfma_f32_32x32x16_bf16 v[80:95], v[44:47], v[24:27], v[80:95]
    v_mfma_f32_32x32x16_bf16 v[96:111], v[44:47], v[28:31], v[96:111]
    ds_read_b128 v[40:43], v9 offset:64
    v_perm_b32 v16, v162, v160, s40
    v_perm_b32 v17, v166, v164, s40
    v_perm_b32 v18, v170, v168, s40
    v_perm_b32 v19, v174, v172, s40
    v_perm_b32 v20, v162, v160, s41
    v_perm_b32 v21, v166, v164, s41
    v_perm_b32 v22, v170, v168, s41
    v_perm_b32 v23, v174, v172, s41
    v_perm_b32 v24, v163, v161, s40
    v_perm_b32 v25, v167, v165, s40
    v_perm_b32 v26, v171, v169, s40
    v_perm_b32 v27, v175, v173, s40
    v_perm_b32 v28, v163, v161, s41
    v_perm_b32 v29, v167, v165, s41
    v_perm_b32 v30, v171, v169, s41
    v_perm_b32 v31, v175, v173, s41
    s_waitcnt lgkmcnt(0)
    v_mfma_f32_32x32x16_bf16 v[48:63], v[40:43], v[16:19], v[48:63]
    v_mfma_f32_32x32x16_bf16 v[64:79], v[40:43], v[20:23], v[64:79]
    v_mfma_f32_32x32x16_bf16 v[80:95], v[40:43], v[24:27], v[80:95]
    v_mfma_f32_32x32x16_bf16 v[96:111], v[40:43], v[28:31], v[96:111]
    ds_read_b128 v[44:47], v9 offset:96
    v_perm_b32 v16, v178, v176, s40
    v_perm_b32 v17, v182, v180, s40
    v_perm_b32 v18, v186, v184, s40
    v_perm_b32 v19, v190, v188, s40
    v_perm_b32 v20, v178, v176, s41
    v_perm_b32 v21, v182, v180, s41
    v_perm_b32 v22, v186, v184, s41
    v_perm_b32 v23, v190, v188, s41
    v_perm_b32 v24, v179, v177, s40
    v_perm_b32 v25, v183, v181, s40
    v_perm_b32 v26, v187, v185, s40
    v_perm_b32 v27, v191, v189, s40
    v_perm_b32 v28, v179, v177, s41
    v_perm_b32 v29, v183, v181, s41
    v_perm_b32 v30, v187, v185, s41
    v_perm_b32 v31, v191, v189, s41
    s_waitcnt lgkmcnt(0)
    v_mfma_f32_32x32x16_bf16 v[48:63], v[44:47], v[16:19], v[48:63]
    v_mfma_f32_32x32x16_bf16 v[64:79], v[44:47], v[20:23], v[64:79]
    v_mfma_f32_32x32x16_bf16 v[80:95], v[44:47], v[24:27], v[80:95]
    v_mfma_f32_32x32x16_bf16 v[96:111], v[44:47], v[28:31], v[96:111]
    ds_read_b128 v[40:43], v9 offset:128
    s_waitcnt vmcnt(0)
    v_perm_b32 v16, v194, v192, s40
    v_perm_b32 v17, v198, v196, s40
    v_perm_b32 v18, v202, v200, s40
    v_perm_b32 v19, v206, v204, s40
    v_perm_b32 v20, v194, v192, s41
    v_perm_b32 v21, v198, v196, s41
    v_perm_b32 v22, v202, v200, s41
    v_perm_b32 v23, v206, v204, s41
    v_perm_b32 v24, v195, v193, s40
    v_perm_b32 v25, v199, v197, s40
    v_perm_b32 v26, v203, v201, s40
    v_perm_b32 v27, v207, v205, s40
    v_perm_b32 v28, v195, v193, s41
    v_perm_b32 v29, v199, v197, s41
    v_perm_b32 v30, v203, v201, s41
    v_perm_b32 v31, v207, v205, s41
    s_waitcnt lgkmcnt(0)
    v_mfma_f32_32x32x16_bf16 v[48:63], v[40:43], v[16:19], v[48:63]
    v_mfma_f32_32x32x16_bf16 v[64:79], v[40:43], v[20:23], v[64:79]
    v_mfma_f32_32x32x16_bf16 v[80:95], v[40:43], v[24:27], v[80:95]
    v_mfma_f32_32x32x16_bf16 v[96:111], v[40:43], v[28:31], v[96:111]
    ds_read_b128 v[44:47], v9 offset:160
    v_perm_b32 v16, v210, v208, s40
    v_perm_b32 v17, v214, v212, s40
    v_perm_b32 v18, v218, v216, s40
    v_perm_b32 v19, v222, v220, s40
    v_perm_b32 v20, v210, v208, s41
    v_perm_b32 v21, v214, v212, s41
    v_perm_b32 v22, v218, v216, s41
    v_perm_b32 v23, v222, v220, s41
    v_perm_b32 v24, v211, v209, s40
    v_perm_b32 v25, v215, v213, s40
    v_perm_b32 v26, v219, v217, s40
    v_perm_b32 v27, v223, v221, s40
    v_perm_b32 v28, v211, v209, s41
    v_perm_b32 v29, v215, v213, s41
    v_perm_b32 v30, v219, v217, s41
    v_perm_b32 v31, v223, v221, s41
    s_waitcnt lgkmcnt(0)
    v_mfma_f32_32x32x16_bf16 v[48:63], v[44:47], v[16:19], v[48:63]
    v_mfma_f32_32x32x16_bf16 v[64:79], v[44:47], v[20:23], v[64:79]
    v_mfma_f32_32x32x16_bf16 v[80:95], v[44:47], v[24:27], v[80:95]
    v_mfma_f32_32x32x16_bf16 v[96:111], v[44:47], v[28:31], v[96:111]
    ds_read_b128 v[40:43], v9 offset:192
    v_perm_b32 v16, v226, v224, s40
    v_perm_b32 v17, v230, v228, s40
    v_perm_b32 v18, v234, v232, s40
    v_perm_b32 v19, v238, v236, s40
    v_perm_b32 v20, v226, v224, s41
    v_perm_b32 v21, v230, v228, s41
    v_perm_b32 v22, v234, v232, s41
    v_perm_b32 v23, v238, v236, s41
    v_perm_b32 v24, v227, v225, s40
    v_perm_b32 v25, v231, v229, s40
    v_perm_b32 v26, v235, v233, s40
    v_perm_b32 v27, v239, v237, s40
    v_perm_b32 v28, v227, v225, s41
    v_perm_b32 v29, v231, v229, s41
    v_perm_b32 v30, v235, v233, s41
    v_perm_b32 v31, v239, v237, s41
    s_waitcnt lgkmcnt(0)
    v_mfma_f32_32x32x16_bf16 v[48:63], v[40:43], v[16:19], v[48:63]
    v_mfma_f32_32x32x16_bf16 v[64:79], v[40:43], v[20:23], v[64:79]
    v_mfma_f32_32x32x16_bf16 v[80:95], v[40:43], v[24:27], v[80:95]
    v_mfma_f32_32x32x16_bf16 v[96:111], v[40:43], v[28:31], v[96:111]
    ds_read_b128 v[44:47], v9 offset:224
    v_perm_b32 v16, v242, v240, s40
    v_perm_b32 v17, v246, v244, s40
    v_perm_b32 v18, v250, v248, s40
    v_perm_b32 v19, v254, v252, s40
    v_perm_b32 v20, v242, v240, s41
    v_perm_b32 v21, v246, v244, s41
    v_perm_b32 v22, v250, v248, s41
    v_perm_b32 v23, v254, v252, s41
    v_perm_b32 v24, v243, v241, s40
    v_perm_b32 v25, v247, v245, s40
    v_perm_b32 v26, v251, v249, s40
    v_perm_b32 v27, v255, v253, s40
    v_perm_b32 v28, v243, v241, s41
    v_perm_b32 v29, v247, v245, s41
    v_perm_b32 v30, v251, v249, s41
    v_perm_b32 v31, v255, v253, s41
    s_waitcnt lgkmcnt(0)
    v_mfma_f32_32x32x16_bf16 v[48:63], v[44:47], v[16:19], v[48:63]
    v_mfma_f32_32x32x16_bf16 v[64:79], v[44:47], v[20:23], v[64:79]
    v_mfma_f32_32x32x16_bf16 v[80:95], v[44:47], v[24:27], v[80:95]
    v_mfma_f32_32x32x16_bf16 v[96:111], v[44:47], v[28:31], v[96:111]
    s_nop 7
    s_nop 7
    s_waitcnt vmcnt(0)
    s_barrier
    v_lshlrev_b32 v9, 4, v2
    s_lshl_b32 s27, s5, 12
    v_add_u32 v10, s27, v9
    ds_write_b128 v10, v[48:51] offset:0
    ds_write_b128 v10, v[64:67] offset:1024
    ds_write_b128 v10, v[80:83] offset:2048
    ds_write_b128 v10, v[96:99] offset:3072
    ds_write_b128 v10, v[52:55] offset:16384
    ds_write_b128 v10, v[68:71] offset:17408
    ds_write_b128 v10, v[84:87] offset:18432
    ds_write_b128 v10, v[100:103] offset:19456
    ds_write_b128 v10, v[56:59] offset:32768
    ds_write_b128 v10, v[72:75] offset:33792
    ds_write_b128 v10, v[88:91] offset:34816
    ds_write_b128 v10, v[104:107] offset:35840
    ds_write_b128 v10, v[60:63] offset:49152
    ds_write_b128 v10, v[76:79] offset:50176
    ds_write_b128 v10, v[92:95] offset:51200
    ds_write_b128 v10, v[108:111] offset:52224
    s_waitcnt lgkmcnt(0)
    s_barrier
    s_lshl_b32 s27, s5, 14
    v_add_u32 v10, s27, v9
    ds_read_b128 v[128:131], v10 offset:0
    ds_read_b128 v[132:135], v10 offset:1024
    ds_read_b128 v[136:139], v10 offset:2048
    ds_read_b128 v[140:143], v10 offset:3072
    ds_read_b128 v[144:147], v10 offset:4096
    ds_read_b128 v[148:151], v10 offset:5120
    ds_read_b128 v[152:155], v10 offset:6144
    ds_read_b128 v[156:159], v10 offset:7168
    ds_read_b128 v[160:163], v10 offset:8192
    ds_read_b128 v[164:167], v10 offset:9216
    ds_read_b128 v[168:171], v10 offset:10240
    ds_read_b128 v[172:175], v10 offset:11264
    ds_read_b128 v[176:179], v10 offset:12288
    ds_read_b128 v[180:183], v10 offset:13312
    ds_read_b128 v[184:187], v10 offset:14336
    ds_read_b128 v[188:191], v10 offset:15360
    s_waitcnt lgkmcnt(0)
    v_add_f32 v48, v128, v144
    v_add_f32 v64, v160, v176
    v_add_f32 v49, v129, v145
    v_add_f32 v65, v161, v177
    v_add_f32 v50, v130, v146
    v_add_f32 v66, v162, v178
    v_add_f32 v51, v131, v147
    v_add_f32 v67, v163, v179
    v_add_f32 v52, v132, v148
    v_add_f32 v68, v164, v180
    v_add_f32 v53, v133, v149
    v_add_f32 v69, v165, v181
    v_add_f32 v54, v134, v150
    v_add_f32 v70, v166, v182
    v_add_f32 v55, v135, v151
    v_add_f32 v71, v167, v183
    v_add_f32 v56, v136, v152
    v_add_f32 v72, v168, v184
    v_add_f32 v57, v137, v153
    v_add_f32 v73, v169, v185
    v_add_f32 v58, v138, v154
    v_add_f32 v74, v170, v186
    v_add_f32 v59, v139, v155
    v_add_f32 v75, v171, v187
    v_add_f32 v60, v140, v156
    v_add_f32 v76, v172, v188
    v_add_f32 v61, v141, v157
    v_add_f32 v77, v173, v189
    v_add_f32 v62, v142, v158
    v_add_f32 v78, v174, v190
    v_add_f32 v63, v143, v159
    v_add_f32 v79, v175, v191
    v_add_f32 v48, v48, v64
    v_add_f32 v49, v49, v65
    v_add_f32 v50, v50, v66
    v_add_f32 v51, v51, v67
    v_add_f32 v52, v52, v68
    v_add_f32 v53, v53, v69
    v_add_f32 v54, v54, v70
    v_add_f32 v55, v55, v71
    v_add_f32 v56, v56, v72
    v_add_f32 v57, v57, v73
    v_add_f32 v58, v58, v74
    v_add_f32 v59, v59, v75
    v_add_f32 v60, v60, v76
    v_add_f32 v61, v61, v77
    v_add_f32 v62, v62, v78
    v_add_f32 v63, v63, v79
    s_add_u32 s28, s6, 0x400000
    s_addc_u32 s29, s7, 0
    s_mov_b32 s30, 0x200000
    s_mov_b32 s31, 0x00020000
    s_sub_u32 s27, s4, 8
    s_lshl_b32 s27, s27, 19
    s_lshl_b32 s32, s24, 1
    s_add_u32 s27, s27, s32
    s_lshr_b32 s32, s5, 1
    s_lshl_b32 s32, s32, 5
    s_add_u32 s27, s27, s32
    s_and_b32 s32, s5, 1
    s_lshl_b32 s32, s32, 3
    s_add_u32 s27, s27, s32
    v_lshlrev_b32 v10, 14, v3
    v_lshl_add_u32 v10, v4, 4, v10
    v_add_u32 v10, s27, v10
    v_cvt_pk_bf16_f32 v16, v48, v49
    v_cvt_pk_bf16_f32 v17, v50, v51
    s_mov_b32 s33, 0
    buffer_store_dwordx2 v[16:17], v10, s[28:31], s33 offen
    s_nop 1
    v_cvt_pk_bf16_f32 v16, v52, v53
    v_cvt_pk_bf16_f32 v17, v54, v55
    s_mov_b32 s33, 4096
    buffer_store_dwordx2 v[16:17], v10, s[28:31], s33 offen
    s_nop 1
    v_cvt_pk_bf16_f32 v16, v56, v57
    v_cvt_pk_bf16_f32 v17, v58, v59
    s_mov_b32 s33, 8192
    buffer_store_dwordx2 v[16:17], v10, s[28:31], s33 offen
    s_nop 1
    v_cvt_pk_bf16_f32 v16, v60, v61
    v_cvt_pk_bf16_f32 v17, v62, v63
    s_mov_b32 s33, 12288
    buffer_store_dwordx2 v[16:17], v10, s[28:31], s33 offen
    s_nop 1
L_end_k1v:
    s_endpgm
.section .rodata,"a"
.p2align 6
.amdhsa_kernel k1_kernel
  .amdhsa_next_free_vgpr 256
  .amdhsa_next_free_sgpr 96
  .amdhsa_accum_offset 256
  .amdhsa_group_segment_fixed_size 0
  .amdhsa_kernarg_size 88
  .amdhsa_user_sgpr_count 2
  .amdhsa_user_sgpr_kernarg_segment_ptr 1
  .amdhsa_system_sgpr_workgroup_id_x 1
.end_amdhsa_kernel
.text

.globl k2attn_kernel
.p2align 8
.type k2attn_kernel,@function
k2attn_kernel:
    s_cmp_ge_u32 s2, 256
    s_cbranch_scc1 L_end_k2attn_kernel
    s_load_dwordx2 s[6:7], s[0:1], 80
    s_lshr_b32 s3, s2, 3
    s_and_b32 s4, s2, 7
    v_lshrrev_b32 v1, 6, v0
    v_and_b32 v2, 63, v0
    v_and_b32 v3, 31, v2
    v_lshrrev_b32 v8, 5, v2
    v_readfirstlane_b32 s5, v1
    s_waitcnt lgkmcnt(0)
    s_add_u32 s16, s6, 0x200000
    s_addc_u32 s17, s7, 0
    s_mov_b32 s18, 0x200000
    s_mov_b32 s19, 0x00020000
    s_add_u32 s20, s6, 0x400000
    s_addc_u32 s21, s7, 0
    s_mov_b32 s22, 0x200000
    s_mov_b32 s23, 0x00020000
    s_mov_b32 s24, s6
    s_mov_b32 s25, s7
    s_mov_b32 s26, 0x200000
    s_mov_b32 s27, 0x00020000
    s_lshl_b32 s8, s3, 16
    v_lshlrev_b32 v9, 4, v0
    s_add_u32 s9, s8, 0
    buffer_load_dwordx4 v[16:19], v9, s[16:19], s9 offen
    buffer_load_dwordx4 v[48:51], v9, s[20:23], s9 offen
    s_add_u32 s9, s8, 8192
    buffer_load_dwordx4 v[20:23], v9, s[16:19], s9 offen
    buffer_load_dwordx4 v[52:55], v9, s[20:23], s9 offen
    s_add_u32 s9, s8, 16384
    buffer_load_dwordx4 v[24:27], v9, s[16:19], s9 offen
    buffer_load_dwordx4 v[56:59], v9, s[20:23], s9 offen
    s_add_u32 s9, s8, 24576
    buffer_load_dwordx4 v[28:31], v9, s[16:19], s9 offen
    buffer_load_dwordx4 v[60:63], v9, s[20:23], s9 offen
    s_add_u32 s9, s8, 32768
    buffer_load_dwordx4 v[32:35], v9, s[16:19], s9 offen
    buffer_load_dwordx4 v[64:67], v9, s[20:23], s9 offen
    s_add_u32 s9, s8, 40960
    buffer_load_dwordx4 v[36:39], v9, s[16:19], s9 offen
    buffer_load_dwordx4 v[68:71], v9, s[20:23], s9 offen
    s_add_u32 s9, s8, 49152
    buffer_load_dwordx4 v[40:43], v9, s[16:19], s9 offen
    buffer_load_dwordx4 v[72:75], v9, s[20:23], s9 offen
    s_add_u32 s9, s8, 57344
    buffer_load_dwordx4 v[44:47], v9, s[16:19], s9 offen
    buffer_load_dwordx4 v[76:79], v9, s[20:23], s9 offen
    s_lshl_b32 s9, s4, 8
    s_lshl_b32 s10, s5, 5
    s_add_u32 s9, s9, s10
    v_add_u32 v10, s9, v3
    v_lshlrev_b32 v11, 5, v10
    v_lshl_add_u32 v11, v8, 4, v11
    buffer_load_dwordx4 v[4:7], v11, s[24:27], s8 offen
    v_lshrrev_b32 v12, 8, v0
    v_mul_u32_u24 v12, 4112, v12
    v_and_b32 v13, 255, v0
    v_lshl_add_u32 v12, v13, 4, v12
    v_add_u32 v12, 0x10000, v12
    v_mov_b32 v80, 0x3f803f80
    v_mov_b32 v81, 0x3f803f80
    v_mov_b32 v82, 0x3f803f80
    v_mov_b32 v83, 0x3f803f80
    v_cmp_gt_u32 vcc, 8, v0
    s_nop 1
    v_cndmask_b32 v80, 0, v80, vcc
    v_cndmask_b32 v81, 0, v81, vcc
    v_cndmask_b32 v82, 0, v82, vcc
    v_cndmask_b32 v83, 0, v83, vcc
    v_min_u32 v13, 15, v0
    v_lshlrev_b32 v13, 4, v13
    v_add_u32 v13, 131328, v13
    ds_write_b128 v13, v[80:83]
    s_waitcnt vmcnt(0)
    ds_write_b128 v9, v[16:19] offset:0
    ds_write_b128 v12, v[48:51] offset:0
    ds_write_b128 v9, v[20:23] offset:8192
    ds_write_b128 v12, v[52:55] offset:8224
    ds_write_b128 v9, v[24:27] offset:16384
    ds_write_b128 v12, v[56:59] offset:16448
    ds_write_b128 v9, v[28:31] offset:24576
    ds_write_b128 v12, v[60:63] offset:24672
    ds_write_b128 v9, v[32:35] offset:32768
    ds_write_b128 v12, v[64:67] offset:32896
    ds_write_b128 v9, v[36:39] offset:40960
    ds_write_b128 v12, v[68:71] offset:41120
    ds_write_b128 v9, v[40:43] offset:49152
    ds_write_b128 v12, v[72:75] offset:49344
    ds_write_b128 v9, v[44:47] offset:57344
    ds_write_b128 v12, v[76:79] offset:57568
    v_lshlrev_b32 v14, 5, v3
    v_lshl_add_u32 v14, v8, 4, v14
    v_mul_u32_u24 v15, 4112, v3
    v_lshl_add_u32 v15, v8, 4, v15
    v_add_u32 v15, 0x10000, v15
    v_mov_b32 v120, 128
    v_cmp_gt_u32 vcc, 16, v3
    v_mov_b32 v121, 131456
    v_mov_b32 v122, 131328
    v_cndmask_b32 v120, 0, v120, vcc
    v_cndmask_b32 v15, v121, v15, vcc
    v_cmp_eq_u32 vcc, 16, v3
    s_nop 1
    v_cndmask_b32 v15, v15, v122, vcc
    v_mov_b32 v16, 0
    v_mov_b32 v17, 0
    v_mov_b32 v18, 0
    v_mov_b32 v19, 0
    v_mov_b32 v20, 0
    v_mov_b32 v21, 0
    v_mov_b32 v22, 0
    v_mov_b32 v23, 0
    v_mov_b32 v24, 0
    v_mov_b32 v25, 0
    v_mov_b32 v26, 0
    v_mov_b32 v27, 0
    v_mov_b32 v28, 0
    v_mov_b32 v29, 0
    v_mov_b32 v30, 0
    v_mov_b32 v31, 0
    v_mov_b32 v32, 0
    v_mov_b32 v33, 0
    v_mov_b32 v34, 0
    v_mov_b32 v35, 0
    v_mov_b32 v36, 0
    v_mov_b32 v37, 0
    v_mov_b32 v38, 0
    v_mov_b32 v39, 0
    v_mov_b32 v40, 0
    v_mov_b32 v41, 0
    v_mov_b32 v42, 0
    v_mov_b32 v43, 0
    v_mov_b32 v44, 0
    v_mov_b32 v45, 0
    v_mov_b32 v46, 0
    v_mov_b32 v47, 0
    s_waitcnt lgkmcnt(0)
    s_barrier
    s_mov_b32 s11, 0
    s_mov_b32 s12, 0x41000000
    ds_read_b128 v[80:83], v14
    ds_read_b128 v[84:87], v14 offset:1024
    ds_read_b128 v[88:91], v15 offset:0
    ds_read_b128 v[92:95], v15 offset:32
    ds_read_b128 v[96:99], v15 offset:64
    ds_read_b128 v[100:103], v15 offset:96
    s_waitcnt lgkmcnt(4)
    v_mfma_f32_32x32x16_bf16 v[48:63], v[80:83], v[4:7], v[16:31]
    v_mfma_f32_32x32x16_bf16 v[64:79], v[84:87], v[4:7], v[16:31]
    v_add_u32 v14, 2048, v14
    v_add_u32 v15, v120, v15
    s_nop 7
    s_nop 3
    v_max3_f32 v123, v48, v49, v50
    v_max3_f32 v123, v123, v51, v52
    v_max3_f32 v123, v123, v53, v54
    v_max3_f32 v123, v123, v55, v56
    v_max3_f32 v123, v123, v57, v58
    v_max3_f32 v123, v123, v59, v60
    v_max3_f32 v123, v123, v61, v62
    v_max3_f32 v123, v123, v63, v64
    v_max3_f32 v123, v123, v65, v66
    v_max3_f32 v123, v123, v67, v68
    v_max3_f32 v123, v123, v69, v70
    v_max3_f32 v123, v123, v71, v72
    v_max3_f32 v123, v123, v73, v74
    v_max3_f32 v123, v123, v75, v76
    v_max3_f32 v123, v123, v77, v78
    v_max_f32 v123, v123, v79
    v_mov_b32 v124, v123
    s_nop 1
    v_permlane32_swap_b32 v123, v124
    v_max_f32 v123, v123, v124
    v_sub_f32 v16, v16, v123
    v_sub_f32 v17, v17, v123
    v_sub_f32 v18, v18, v123
    v_sub_f32 v19, v19, v123
    v_sub_f32 v20, v20, v123
    v_sub_f32 v21, v21, v123
    v_sub_f32 v22, v22, v123
    v_sub_f32 v23, v23, v123
    v_sub_f32 v24, v24, v123
    v_sub_f32 v25, v25, v123
    v_sub_f32 v26, v26, v123
    v_sub_f32 v27, v27, v123
    v_sub_f32 v28, v28, v123
    v_sub_f32 v29, v29, v123
    v_sub_f32 v30, v30, v123
    v_sub_f32 v31, v31, v123
    v_sub_f32 v48, v48, v123
    v_sub_f32 v49, v49, v123
    v_sub_f32 v50, v50, v123
    v_sub_f32 v51, v51, v123
    v_sub_f32 v52, v52, v123
    v_sub_f32 v53, v53, v123
    v_sub_f32 v54, v54, v123
    v_sub_f32 v55, v55, v123
    v_sub_f32 v56, v56, v123
    v_sub_f32 v57, v57, v123
    v_sub_f32 v58, v58, v123
    v_sub_f32 v59, v59, v123
    v_sub_f32 v60, v60, v123
    v_sub_f32 v61, v61, v123
    v_sub_f32 v62, v62, v123
    v_sub_f32 v63, v63, v123
    v_sub_f32 v64, v64, v123
    v_sub_f32 v65, v65, v123
    v_sub_f32 v66, v66, v123
    v_sub_f32 v67, v67, v123
    v_sub_f32 v68, v68, v123
    v_sub_f32 v69, v69, v123
    v_sub_f32 v70, v70, v123
    v_sub_f32 v71, v71, v123
    v_sub_f32 v72, v72, v123
    v_sub_f32 v73, v73, v123
    v_sub_f32 v74, v74, v123
    v_sub_f32 v75, v75, v123
    v_sub_f32 v76, v76, v123
    v_sub_f32 v77, v77, v123
    v_sub_f32 v78, v78, v123
    v_sub_f32 v79, v79, v123
    v_exp_f32 v48, v48
    v_exp_f32 v49, v49
    v_exp_f32 v50, v50
    v_exp_f32 v51, v51
    v_exp_f32 v52, v52
    v_exp_f32 v53, v53
    v_exp_f32 v54, v54
    v_exp_f32 v55, v55
    v_exp_f32 v56, v56
    v_exp_f32 v57, v57
    v_exp_f32 v58, v58
    v_exp_f32 v59, v59
    v_exp_f32 v60, v60
    v_exp_f32 v61, v61
    v_exp_f32 v62, v62
    v_exp_f32 v63, v63
    v_exp_f32 v64, v64
    v_exp_f32 v65, v65
    v_exp_f32 v66, v66
    v_exp_f32 v67, v67
    v_exp_f32 v68, v68
    v_exp_f32 v69, v69
    v_exp_f32 v70, v70
    v_exp_f32 v71, v71
    v_exp_f32 v72, v72
    v_exp_f32 v73, v73
    v_exp_f32 v74, v74
    v_exp_f32 v75, v75
    v_exp_f32 v76, v76
    v_exp_f32 v77, v77
    v_exp_f32 v78, v78
    v_exp_f32 v79, v79
    v_cvt_pk_bf16_f32 v104, v48, v49
    v_cvt_pk_bf16_f32 v105, v50, v51
    v_cvt_pk_bf16_f32 v106, v52, v53
    v_cvt_pk_bf16_f32 v107, v54, v55
    v_cvt_pk_bf16_f32 v108, v56, v57
    v_cvt_pk_bf16_f32 v109, v58, v59
    v_cvt_pk_bf16_f32 v110, v60, v61
    v_cvt_pk_bf16_f32 v111, v62, v63
    v_cvt_pk_bf16_f32 v112, v64, v65
    v_cvt_pk_bf16_f32 v113, v66, v67
    v_cvt_pk_bf16_f32 v114, v68, v69
    v_cvt_pk_bf16_f32 v115, v70, v71
    v_cvt_pk_bf16_f32 v116, v72, v73
    v_cvt_pk_bf16_f32 v117, v74, v75
    v_cvt_pk_bf16_f32 v118, v76, v77
    v_cvt_pk_bf16_f32 v119, v78, v79
    s_waitcnt lgkmcnt(0)
    s_nop 1
    v_mfma_f32_32x32x16_bf16 v[32:47], v[88:91], v[104:107], v[32:47]
    v_mfma_f32_32x32x16_bf16 v[32:47], v[92:95], v[108:111], v[32:47]
    v_mfma_f32_32x32x16_bf16 v[32:47], v[96:99], v[112:115], v[32:47]
    v_mfma_f32_32x32x16_bf16 v[32:47], v[100:103], v[116:119], v[32:47]
L_loop_k2attn_kernel:
    ds_read_b128 v[80:83], v14
    ds_read_b128 v[84:87], v14 offset:1024
    ds_read_b128 v[88:91], v15 offset:0
    ds_read_b128 v[92:95], v15 offset:32
    ds_read_b128 v[96:99], v15 offset:64
    ds_read_b128 v[100:103], v15 offset:96
    s_waitcnt lgkmcnt(4)
    v_mfma_f32_32x32x16_bf16 v[48:63], v[80:83], v[4:7], v[16:31]
    v_mfma_f32_32x32x16_bf16 v[64:79], v[84:87], v[4:7], v[16:31]
    v_add_u32 v14, 2048, v14
    v_add_u32 v15, v120, v15
    s_nop 7
    s_nop 3
    v_max3_f32 v123, v48, v49, v50
    v_max3_f32 v123, v123, v51, v52
    v_max3_f32 v123, v123, v53, v54
    v_max3_f32 v123, v123, v55, v56
    v_max3_f32 v123, v123, v57, v58
    v_max3_f32 v123, v123, v59, v60
    v_max3_f32 v123, v123, v61, v62
    v_max3_f32 v123, v123, v63, v64
    v_max3_f32 v123, v123, v65, v66
    v_max3_f32 v123, v123, v67, v68
    v_max3_f32 v123, v123, v69, v70
    v_max3_f32 v123, v123, v71, v72
    v_max3_f32 v123, v123, v73, v74
    v_max3_f32 v123, v123, v75, v76
    v_max3_f32 v123, v123, v77, v78
    v_max_f32 v123, v123, v79
    v_mov_b32 v124, v123
    s_nop 1
    v_permlane32_swap_b32 v123, v124
    v_max_f32 v123, v123, v124
    v_cmp_lt_f32 vcc, s12, v123
    s_cbranch_vccz L_fast_k2attn_kernel
    v_max_f32 v123, 0, v123
    v_sub_f32 v124, 0, v123
    v_exp_f32 v124, v124
    s_nop 0
    v_mul_f32 v32, v32, v124
    v_mul_f32 v33, v33, v124
    v_mul_f32 v34, v34, v124
    v_mul_f32 v35, v35, v124
    v_mul_f32 v36, v36, v124
    v_mul_f32 v37, v37, v124
    v_mul_f32 v38, v38, v124
    v_mul_f32 v39, v39, v124
    v_mul_f32 v40, v40, v124
    v_mul_f32 v41, v41, v124
    v_mul_f32 v42, v42, v124
    v_mul_f32 v43, v43, v124
    v_mul_f32 v44, v44, v124
    v_mul_f32 v45, v45, v124
    v_mul_f32 v46, v46, v124
    v_mul_f32 v47, v47, v124
    v_sub_f32 v16, v16, v123
    v_sub_f32 v17, v17, v123
    v_sub_f32 v18, v18, v123
    v_sub_f32 v19, v19, v123
    v_sub_f32 v20, v20, v123
    v_sub_f32 v21, v21, v123
    v_sub_f32 v22, v22, v123
    v_sub_f32 v23, v23, v123
    v_sub_f32 v24, v24, v123
    v_sub_f32 v25, v25, v123
    v_sub_f32 v26, v26, v123
    v_sub_f32 v27, v27, v123
    v_sub_f32 v28, v28, v123
    v_sub_f32 v29, v29, v123
    v_sub_f32 v30, v30, v123
    v_sub_f32 v31, v31, v123
    v_sub_f32 v48, v48, v123
    v_sub_f32 v49, v49, v123
    v_sub_f32 v50, v50, v123
    v_sub_f32 v51, v51, v123
    v_sub_f32 v52, v52, v123
    v_sub_f32 v53, v53, v123
    v_sub_f32 v54, v54, v123
    v_sub_f32 v55, v55, v123
    v_sub_f32 v56, v56, v123
    v_sub_f32 v57, v57, v123
    v_sub_f32 v58, v58, v123
    v_sub_f32 v59, v59, v123
    v_sub_f32 v60, v60, v123
    v_sub_f32 v61, v61, v123
    v_sub_f32 v62, v62, v123
    v_sub_f32 v63, v63, v123
    v_sub_f32 v64, v64, v123
    v_sub_f32 v65, v65, v123
    v_sub_f32 v66, v66, v123
    v_sub_f32 v67, v67, v123
    v_sub_f32 v68, v68, v123
    v_sub_f32 v69, v69, v123
    v_sub_f32 v70, v70, v123
    v_sub_f32 v71, v71, v123
    v_sub_f32 v72, v72, v123
    v_sub_f32 v73, v73, v123
    v_sub_f32 v74, v74, v123
    v_sub_f32 v75, v75, v123
    v_sub_f32 v76, v76, v123
    v_sub_f32 v77, v77, v123
    v_sub_f32 v78, v78, v123
    v_sub_f32 v79, v79, v123
L_fast_k2attn_kernel:
    v_exp_f32 v48, v48
    v_exp_f32 v49, v49
    v_exp_f32 v50, v50
    v_exp_f32 v51, v51
    v_exp_f32 v52, v52
    v_exp_f32 v53, v53
    v_exp_f32 v54, v54
    v_exp_f32 v55, v55
    v_exp_f32 v56, v56
    v_exp_f32 v57, v57
    v_exp_f32 v58, v58
    v_exp_f32 v59, v59
    v_exp_f32 v60, v60
    v_exp_f32 v61, v61
    v_exp_f32 v62, v62
    v_exp_f32 v63, v63
    v_exp_f32 v64, v64
    v_exp_f32 v65, v65
    v_exp_f32 v66, v66
    v_exp_f32 v67, v67
    v_exp_f32 v68, v68
    v_exp_f32 v69, v69
    v_exp_f32 v70, v70
    v_exp_f32 v71, v71
    v_exp_f32 v72, v72
    v_exp_f32 v73, v73
    v_exp_f32 v74, v74
    v_exp_f32 v75, v75
    v_exp_f32 v76, v76
    v_exp_f32 v77, v77
    v_exp_f32 v78, v78
    v_exp_f32 v79, v79
    v_cvt_pk_bf16_f32 v104, v48, v49
    v_cvt_pk_bf16_f32 v105, v50, v51
    v_cvt_pk_bf16_f32 v106, v52, v53
    v_cvt_pk_bf16_f32 v107, v54, v55
    v_cvt_pk_bf16_f32 v108, v56, v57
    v_cvt_pk_bf16_f32 v109, v58, v59
    v_cvt_pk_bf16_f32 v110, v60, v61
    v_cvt_pk_bf16_f32 v111, v62, v63
    v_cvt_pk_bf16_f32 v112, v64, v65
    v_cvt_pk_bf16_f32 v113, v66, v67
    v_cvt_pk_bf16_f32 v114, v68, v69
    v_cvt_pk_bf16_f32 v115, v70, v71
    v_cvt_pk_bf16_f32 v116, v72, v73
    v_cvt_pk_bf16_f32 v117, v74, v75
    v_cvt_pk_bf16_f32 v118, v76, v77
    v_cvt_pk_bf16_f32 v119, v78, v79
    s_waitcnt lgkmcnt(0)
    s_nop 1
    v_mfma_f32_32x32x16_bf16 v[32:47], v[88:91], v[104:107], v[32:47]
    v_mfma_f32_32x32x16_bf16 v[32:47], v[92:95], v[108:111], v[32:47]
    v_mfma_f32_32x32x16_bf16 v[32:47], v[96:99], v[112:115], v[32:47]
    v_mfma_f32_32x32x16_bf16 v[32:47], v[100:103], v[116:119], v[32:47]
    s_add_u32 s11, s11, 1
    s_cmp_lt_u32 s11, 31
    s_cbranch_scc1 L_loop_k2attn_kernel
    s_nop 7
    s_nop 7
    v_mov_b32 v124, v40
    s_nop 1
    v_permlane32_swap_b32 v40, v124
    v_rcp_f32 v40, v40
    s_nop 0
    v_mul_f32 v32, v32, v40
    v_mul_f32 v33, v33, v40
    v_mul_f32 v34, v34, v40
    v_mul_f32 v35, v35, v40
    v_mul_f32 v36, v36, v40
    v_mul_f32 v37, v37, v40
    v_mul_f32 v38, v38, v40
    v_mul_f32 v39, v39, v40
    v_cvt_pk_bf16_f32 v48, v32, v33
    v_cvt_pk_bf16_f32 v49, v34, v35
    v_cvt_pk_bf16_f32 v50, v36, v37
    v_cvt_pk_bf16_f32 v51, v38, v39
    s_add_u32 s16, s6, 0x600000
    s_addc_u32 s17, s7, 0
    s_mov_b32 s18, 0x200000
    s_mov_b32 s19, 0x00020000
    v_lshlrev_b32 v11, 10, v10
    v_lshl_add_u32 v11, v8, 3, v11
    s_lshl_b32 s9, s3, 5
    buffer_store_dwordx2 v[48:49], v11, s[16:19], s9 offen
    buffer_store_dwordx2 v[50:51], v11, s[16:19], s9 offen offset:16
L_end_k2attn_kernel:
    s_endpgm
.section .rodata,"a"
.p2align 6
.amdhsa_kernel k2attn_kernel
  .amdhsa_next_free_vgpr 128
  .amdhsa_next_free_sgpr 96
  .amdhsa_accum_offset 128
  .amdhsa_group_segment_fixed_size 0
  .amdhsa_kernarg_size 88
  .amdhsa_user_sgpr_count 2
  .amdhsa_user_sgpr_kernarg_segment_ptr 1
  .amdhsa_system_sgpr_workgroup_id_x 1
.end_amdhsa_kernel
.text

.globl k3_kernel
.p2align 8
.type k3_kernel,@function
k3_kernel:
    s_and_b32 s3, s2, 63
    s_lshr_b32 s4, s2, 6
    s_cmp_ge_u32 s4, 4
    s_cbranch_scc1 L_end_k3_kernel
    s_load_dwordx2 s[6:7], s[0:1], 80
    s_load_dwordx2 s[8:9], s[0:1], 16
    s_load_dwordx2 s[10:11], s[0:1], 0
    s_load_dwordx2 s[12:13], s[0:1], 64
    v_lshrrev_b32 v1, 6, v0
    v_and_b32 v2, 63, v0
    v_and_b32 v3, 31, v2
    v_lshrrev_b32 v4, 5, v2
    v_readfirstlane_b32 s5, v1
    s_mov_b32 s40, 0x05040100
    s_mov_b32 s41, 0x07060302
    s_waitcnt lgkmcnt(0)
    s_add_u32 s16, s6, 0x600000
    s_addc_u32 s17, s7, 0
    s_mov_b32 s18, 0x200000
    s_mov_b32 s19, 0x00020000
    s_mov_b32 s20, s8
    s_mov_b32 s21, s9
    s_mov_b32 s22, 0x80000
    s_mov_b32 s23, 0x00020000
    s_lshl_b32 s24, s3, 5
    s_mul_i32 s25, s5, 8
    s_lshl_b32 s26, s4, 8
    s_mul_i32 s27, s25, 16384
    s_add_u32 s26, s26, s27
    v_mul_u32_u24 v5, 8192, v4
    v_lshl_add_u32 v5, v3, 3, v5
    v_add_u32 v8, s24, v3
    v_mul_u32_u24 v8, 1024, v8
    v_lshl_add_u32 v8, v4, 4, v8
    s_lshl_b32 s27, s25, 5
    v_add_u32 v12, s27, v8
    buffer_load_dwordx4 v[112:115], v12, s[16:19], 0 offen offset:0
    buffer_load_dwordx4 v[116:119], v12, s[16:19], 0 offen offset:32
    buffer_load_dwordx4 v[120:123], v12, s[16:19], 0 offen offset:64
    buffer_load_dwordx4 v[124:127], v12, s[16:19], 0 offen offset:96
    buffer_load_dwordx2 v[128:129], v5, s[20:23], s26 offen offset:0
    buffer_load_dwordx2 v[130:131], v5, s[20:23], s26 offen offset:1024
    buffer_load_dwordx2 v[132:133], v5, s[20:23], s26 offen offset:2048
    buffer_load_dwordx2 v[134:135], v5, s[20:23], s26 offen offset:3072
    s_add_u32 s28, s26, 0x1000
    buffer_load_dwordx2 v[136:137], v5, s[20:23], s28 offen
    s_add_u32 s28, s26, 0x1400
    buffer_load_dwordx2 v[138:139], v5, s[20:23], s28 offen
    s_add_u32 s28, s26, 0x1800
    buffer_load_dwordx2 v[140:141], v5, s[20:23], s28 offen
    s_add_u32 s28, s26, 0x1c00
    buffer_load_dwordx2 v[142:143], v5, s[20:23], s28 offen
    s_add_u32 s28, s26, 0x4000
    buffer_load_dwordx2 v[144:145], v5, s[20:23], s28 offen
    s_add_u32 s28, s26, 0x4400
    buffer_load_dwordx2 v[146:147], v5, s[20:23], s28 offen
    s_add_u32 s28, s26, 0x4800
    buffer_load_dwordx2 v[148:149], v5, s[20:23], s28 offen
    s_add_u32 s28, s26, 0x4c00
    buffer_load_dwordx2 v[150:151], v5, s[20:23], s28 offen
    s_add_u32 s28, s26, 0x5000
    buffer_load_dwordx2 v[152:153], v5, s[20:23], s28 offen
    s_add_u32 s28, s26, 0x5400
    buffer_load_dwordx2 v[154:155], v5, s[20:23], s28 offen
    s_add_u32 s28, s26, 0x5800
    buffer_load_dwordx2 v[156:157], v5, s[20:23], s28 offen
    s_add_u32 s28, s26, 0x5c00
    buffer_load_dwordx2 v[158:159], v5, s[20:23], s28 offen
    s_add_u32 s28, s26, 0x8000
    buffer_load_dwordx2 v[160:161], v5, s[20:23], s28 offen
    s_add_u32 s28, s26, 0x8400
    buffer_load_dwordx2 v[162:163], v5, s[20:23], s28 offen
    s_add_u32 s28, s26, 0x8800
    buffer_load_dwordx2 v[164:165], v5, s[20:23], s28 offen
    s_add_u32 s28, s26, 0x8c00
    buffer_load_dwordx2 v[166:167], v5, s[20:23], s28 offen
    s_add_u32 s28, s26, 0x9000
    buffer_load_dwordx2 v[168:169], v5, s[20:23], s28 offen
    s_add_u32 s28, s26, 0x9400
    buffer_load_dwordx2 v[170:171], v5, s[20:23], s28 offen
    s_add_u32 s28, s26, 0x9800
    buffer_load_dwordx2 v[172:173], v5, s[20:23], s28 offen
    s_add_u32 s28, s26, 0x9c00
    buffer_load_dwordx2 v[174:175], v5, s[20:23], s28 offen
    s_add_u32 s28, s26, 0xc000
    buffer_load_dwordx2 v[176:177], v5, s[20:23], s28 offen
    s_add_u32 s28, s26, 0xc400
    buffer_load_dwordx2 v[178:179], v5, s[20:23], s28 offen
    s_add_u32 s28, s26, 0xc800
    buffer_load_dwordx2 v[180:181], v5, s[20:23], s28 offen
    s_add_u32 s28, s26, 0xcc00
    buffer_load_dwordx2 v[182:183], v5, s[20:23], s28 offen
    s_add_u32 s28, s26, 0xd000
    buffer_load_dwordx2 v[184:185], v5, s[20:23], s28 offen
    s_add_u32 s28, s26, 0xd400
    buffer_load_dwordx2 v[186:187], v5, s[20:23], s28 offen
    s_add_u32 s28, s26, 0xd800
    buffer_load_dwordx2 v[188:189], v5, s[20:23], s28 offen
    s_add_u32 s28, s26, 0xdc00
    buffer_load_dwordx2 v[190:191], v5, s[20:23], s28 offen
    buffer_load_dwordx4 v[32:35], v12, s[16:19], 0 offen offset:128
    buffer_load_dwordx4 v[36:39], v12, s[16:19], 0 offen offset:160
    buffer_load_dwordx4 v[40:43], v12, s[16:19], 0 offen offset:192
    buffer_load_dwordx4 v[44:47], v12, s[16:19], 0 offen offset:224
    s_add_u32 s28, s26, 0x10000
    buffer_load_dwordx2 v[192:193], v5, s[20:23], s28 offen
    s_add_u32 s28, s26, 0x10400
    buffer_load_dwordx2 v[194:195], v5, s[20:23], s28 offen
    s_add_u32 s28, s26, 0x10800
    buffer_load_dwordx2 v[196:197], v5, s[20:23], s28 offen
    s_add_u32 s28, s26, 0x10c00
    buffer_load_dwordx2 v[198:199], v5, s[20:23], s28 offen
    s_add_u32 s28, s26, 0x11000
    buffer_load_dwordx2 v[200:201], v5, s[20:23], s28 offen
    s_add_u32 s28, s26, 0x11400
    buffer_load_dwordx2 v[202:203], v5, s[20:23], s28 offen
    s_add_u32 s28, s26, 0x11800
    buffer_load_dwordx2 v[204:205], v5, s[20:23], s28 offen
    s_add_u32 s28, s26, 0x11c00
    buffer_load_dwordx2 v[206:207], v5, s[20:23], s28 offen
    s_add_u32 s28, s26, 0x14000
    buffer_load_dwordx2 v[208:209], v5, s[20:23], s28 offen
    s_add_u32 s28, s26, 0x14400
    buffer_load_dwordx2 v[210:211], v5, s[20:23], s28 offen
    s_add_u32 s28, s26, 0x14800
    buffer_load_dwordx2 v[212:213], v5, s[20:23], s28 offen
    s_add_u32 s28, s26, 0x14c00
    buffer_load_dwordx2 v[214:215], v5, s[20:23], s28 offen
    s_add_u32 s28, s26, 0x15000
    buffer_load_dwordx2 v[216:217], v5, s[20:23], s28 offen
    s_add_u32 s28, s26, 0x15400
    buffer_load_dwordx2 v[218:219], v5, s[20:23], s28 offen
    s_add_u32 s28, s26, 0x15800
    buffer_load_dwordx2 v[220:221], v5, s[20:23], s28 offen
    s_add_u32 s28, s26, 0x15c00
    buffer_load_dwordx2 v[222:223], v5, s[20:23], s28 offen
    s_add_u32 s28, s26, 0x18000
    buffer_load_dwordx2 v[224:225], v5, s[20:23], s28 offen
    s_add_u32 s28, s26, 0x18400
    buffer_load_dwordx2 v[226:227], v5, s[20:23], s28 offen
    s_add_u32 s28, s26, 0x18800
    buffer_load_dwordx2 v[228:229], v5, s[20:23], s28 offen
    s_add_u32 s28, s26, 0x18c00
    buffer_load_dwordx2 v[230:231], v5, s[20:23], s28 offen
    s_add_u32 s28, s26, 0x19000
    buffer_load_dwordx2 v[232:233], v5, s[20:23], s28 offen
    s_add_u32 s28, s26, 0x19400
    buffer_load_dwordx2 v[234:235], v5, s[20:23], s28 offen
    s_add_u32 s28, s26, 0x19800
    buffer_load_dwordx2 v[236:237], v5, s[20:23], s28 offen
    s_add_u32 s28, s26, 0x19c00
    buffer_load_dwordx2 v[238:239], v5, s[20:23], s28 offen
    s_add_u32 s28, s26, 0x1c000
    buffer_load_dwordx2 v[240:241], v5, s[20:23], s28 offen
    s_add_u32 s28, s26, 0x1c400
    buffer_load_dwordx2 v[242:243], v5, s[20:23], s28 offen
    s_add_u32 s28, s26, 0x1c800
    buffer_load_dwordx2 v[244:245], v5, s[20:23], s28 offen
    s_add_u32 s28, s26, 0x1cc00
    buffer_load_dwordx2 v[246:247], v5, s[20:23], s28 offen
    s_add_u32 s28, s26, 0x1d000
    buffer_load_dwordx2 v[248:249], v5, s[20:23], s28 offen
    s_add_u32 s28, s26, 0x1d400
    buffer_load_dwordx2 v[250:251], v5, s[20:23], s28 offen
    s_add_u32 s28, s26, 0x1d800
    buffer_load_dwordx2 v[252:253], v5, s[20:23], s28 offen
    s_add_u32 s28, s26, 0x1dc00
    buffer_load_dwordx2 v[254:255], v5, s[20:23], s28 offen
    v_mov_b32 v48, 0
    v_mov_b32 v49, 0
    v_mov_b32 v50, 0
    v_mov_b32 v51, 0
    v_mov_b32 v52, 0
    v_mov_b32 v53, 0
    v_mov_b32 v54, 0
    v_mov_b32 v55, 0
    v_mov_b32 v56, 0
    v_mov_b32 v57, 0
    v_mov_b32 v58, 0
    v_mov_b32 v59, 0
    v_mov_b32 v60, 0
    v_mov_b32 v61, 0
    v_mov_b32 v62, 0
    v_mov_b32 v63, 0
    v_mov_b32 v64, 0
    v_mov_b32 v65, 0
    v_mov_b32 v66, 0
    v_mov_b32 v67, 0
    v_mov_b32 v68, 0
    v_mov_b32 v69, 0
    v_mov_b32 v70, 0
    v_mov_b32 v71, 0
    v_mov_b32 v72, 0
    v_mov_b32 v73, 0
    v_mov_b32 v74, 0
    v_mov_b32 v75, 0
    v_mov_b32 v76, 0
    v_mov_b32 v77, 0
    v_mov_b32 v78, 0
    v_mov_b32 v79, 0
    v_mov_b32 v80, 0
    v_mov_b32 v81, 0
    v_mov_b32 v82, 0
    v_mov_b32 v83, 0
    v_mov_b32 v84, 0
    v_mov_b32 v85, 0
    v_mov_b32 v86, 0
    v_mov_b32 v87, 0
    v_mov_b32 v88, 0
    v_mov_b32 v89, 0
    v_mov_b32 v90, 0
    v_mov_b32 v91, 0
    v_mov_b32 v92, 0
    v_mov_b32 v93, 0
    v_mov_b32 v94, 0
    v_mov_b32 v95, 0
    v_mov_b32 v96, 0
    v_mov_b32 v97, 0
    v_mov_b32 v98, 0
    v_mov_b32 v99, 0
    v_mov_b32 v100, 0
    v_mov_b32 v101, 0
    v_mov_b32 v102, 0
    v_mov_b32 v103, 0
    v_mov_b32 v104, 0
    v_mov_b32 v105, 0
    v_mov_b32 v106, 0
    v_mov_b32 v107, 0
    v_mov_b32 v108, 0
    v_mov_b32 v109, 0
    v_mov_b32 v110, 0
    v_mov_b32 v111, 0
    s_waitcnt vmcnt(36)
    v_perm_b32 v16, v130, v128, s40
    v_perm_b32 v17, v134, v132, s40
    v_perm_b32 v18, v138, v136, s40
    v_perm_b32 v19, v142, v140, s40
    v_perm_b32 v20, v130, v128, s41
    v_perm_b32 v21, v134, v132, s41
    v_perm_b32 v22, v138, v136, s41
    v_perm_b32 v23, v142, v140, s41
    v_perm_b32 v24, v131, v129, s40
    v_perm_b32 v25, v135, v133, s40
    v_perm_b32 v26, v139, v137, s40
    v_perm_b32 v27, v143, v141, s40
    v_perm_b32 v28, v131, v129, s41
    v_perm_b32 v29, v135, v133, s41
    v_perm_b32 v30, v139, v137, s41
    v_perm_b32 v31, v143, v141, s41
    s_nop 1
    v_mfma_f32_32x32x16_bf16 v[48:63], v[16:19], v[112:115], v[48:63]
    v_mfma_f32_32x32x16_bf16 v[64:79], v[20:23], v[112:115], v[64:79]
    v_mfma_f32_32x32x16_bf16 v[80:95], v[24:27], v[112:115], v[80:95]
    v_mfma_f32_32x32x16_bf16 v[96:111], v[28:31], v[112:115], v[96:111]
    v_perm_b32 v16, v146, v144, s40
    v_perm_b32 v17, v150, v148, s40
    v_perm_b32 v18, v154, v152, s40
    v_perm_b32 v19, v158, v156, s40
    v_perm_b32 v20, v146, v144, s41
    v_perm_b32 v21, v150, v148, s41
    v_perm_b32 v22, v154, v152, s41
    v_perm_b32 v23, v158, v156, s41
    v_perm_b32 v24, v147, v145, s40
    v_perm_b32 v25, v151, v149, s40
    v_perm_b32 v26, v155, v153, s40
    v_perm_b32 v27, v159, v157, s40
    v_perm_b32 v28, v147, v145, s41
    v_perm_b32 v29, v151, v149, s41
    v_perm_b32 v30, v155, v153, s41
    v_perm_b32 v31, v159, v157, s41
    s_nop 1
    v_mfma_f32_32x32x16_bf16 v[48:63], v[16:19], v[116:119], v[48:63]
    v_mfma_f32_32x32x16_bf16 v[64:79], v[20:23], v[116:119], v[64:79]
    v_mfma_f32_32x32x16_bf16 v[80:95], v[24:27], v[116:119], v[80:95]
    v_mfma_f32_32x32x16_bf16 v[96:111], v[28:31], v[116:119], v[96:111]
    v_perm_b32 v16, v162, v160, s40
    v_perm_b32 v17, v166, v164, s40
    v_perm_b32 v18, v170, v168, s40
    v_perm_b32 v19, v174, v172, s40
    v_perm_b32 v20, v162, v160, s41
    v_perm_b32 v21, v166, v164, s41
    v_perm_b32 v22, v170, v168, s41
    v_perm_b32 v23, v174, v172, s41
    v_perm_b32 v24, v163, v161, s40
    v_perm_b32 v25, v167, v165, s40
    v_perm_b32 v26, v171, v169, s40
    v_perm_b32 v27, v175, v173, s40
    v_perm_b32 v28, v163, v161, s41
    v_perm_b32 v29, v167, v165, s41
    v_perm_b32 v30, v171, v169, s41
    v_perm_b32 v31, v175, v173, s41
    s_nop 1
    v_mfma_f32_32x32x16_bf16 v[48:63], v[16:19], v[120:123], v[48:63]
    v_mfma_f32_32x32x16_bf16 v[64:79], v[20:23], v[120:123], v[64:79]
    v_mfma_f32_32x32x16_bf16 v[80:95], v[24:27], v[120:123], v[80:95]
    v_mfma_f32_32x32x16_bf16 v[96:111], v[28:31], v[120:123], v[96:111]
    v_perm_b32 v16, v178, v176, s40
    v_perm_b32 v17, v182, v180, s40
    v_perm_b32 v18, v186, v184, s40
    v_perm_b32 v19, v190, v188, s40
    v_perm_b32 v20, v178, v176, s41
    v_perm_b32 v21, v182, v180, s41
    v_perm_b32 v22, v186, v184, s41
    v_perm_b32 v23, v190, v188, s41
    v_perm_b32 v24, v179, v177, s40
    v_perm_b32 v25, v183, v181, s40
    v_perm_b32 v26, v187, v185, s40
    v_perm_b32 v27, v191, v189, s40
    v_perm_b32 v28, v179, v177, s41
    v_perm_b32 v29, v183, v181, s41
    v_perm_b32 v30, v187, v185, s41
    v_perm_b32 v31, v191, v189, s41
    s_nop 1
    v_mfma_f32_32x32x16_bf16 v[48:63], v[16:19], v[124:127], v[48:63]
    v_mfma_f32_32x32x16_bf16 v[64:79], v[20:23], v[124:127], v[64:79]
    v_mfma_f32_32x32x16_bf16 v[80:95], v[24:27], v[124:127], v[80:95]
    v_mfma_f32_32x32x16_bf16 v[96:111], v[28:31], v[124:127], v[96:111]
    s_waitcnt vmcnt(0)
    v_perm_b32 v16, v194, v192, s40
    v_perm_b32 v17, v198, v196, s40
    v_perm_b32 v18, v202, v200, s40
    v_perm_b32 v19, v206, v204, s40
    v_perm_b32 v20, v194, v192, s41
    v_perm_b32 v21, v198, v196, s41
    v_perm_b32 v22, v202, v200, s41
    v_perm_b32 v23, v206, v204, s41
    v_perm_b32 v24, v195, v193, s40
    v_perm_b32 v25, v199, v197, s40
    v_perm_b32 v26, v203, v201, s40
    v_perm_b32 v27, v207, v205, s40
    v_perm_b32 v28, v195, v193, s41
    v_perm_b32 v29, v199, v197, s41
    v_perm_b32 v30, v203, v201, s41
    v_perm_b32 v31, v207, v205, s41
    s_nop 1
    v_mfma_f32_32x32x16_bf16 v[48:63], v[16:19], v[32:35], v[48:63]
    v_mfma_f32_32x32x16_bf16 v[64:79], v[20:23], v[32:35], v[64:79]
    v_mfma_f32_32x32x16_bf16 v[80:95], v[24:27], v[32:35], v[80:95]
    v_mfma_f32_32x32x16_bf16 v[96:111], v[28:31], v[32:35], v[96:111]
    v_perm_b32 v16, v210, v208, s40
    v_perm_b32 v17, v214, v212, s40
    v_perm_b32 v18, v218, v216, s40
    v_perm_b32 v19, v222, v220, s40
    v_perm_b32 v20, v210, v208, s41
    v_perm_b32 v21, v214, v212, s41
    v_perm_b32 v22, v218, v216, s41
    v_perm_b32 v23, v222, v220, s41
    v_perm_b32 v24, v211, v209, s40
    v_perm_b32 v25, v215, v213, s40
    v_perm_b32 v26, v219, v217, s40
    v_perm_b32 v27, v223, v221, s40
    v_perm_b32 v28, v211, v209, s41
    v_perm_b32 v29, v215, v213, s41
    v_perm_b32 v30, v219, v217, s41
    v_perm_b32 v31, v223, v221, s41
    s_nop 1
    v_mfma_f32_32x32x16_bf16 v[48:63], v[16:19], v[36:39], v[48:63]
    v_mfma_f32_32x32x16_bf16 v[64:79], v[20:23], v[36:39], v[64:79]
    v_mfma_f32_32x32x16_bf16 v[80:95], v[24:27], v[36:39], v[80:95]
    v_mfma_f32_32x32x16_bf16 v[96:111], v[28:31], v[36:39], v[96:111]
    v_perm_b32 v16, v226, v224, s40
    v_perm_b32 v17, v230, v228, s40
    v_perm_b32 v18, v234, v232, s40
    v_perm_b32 v19, v238, v236, s40
    v_perm_b32 v20, v226, v224, s41
    v_perm_b32 v21, v230, v228, s41
    v_perm_b32 v22, v234, v232, s41
    v_perm_b32 v23, v238, v236, s41
    v_perm_b32 v24, v227, v225, s40
    v_perm_b32 v25, v231, v229, s40
    v_perm_b32 v26, v235, v233, s40
    v_perm_b32 v27, v239, v237, s40
    v_perm_b32 v28, v227, v225, s41
    v_perm_b32 v29, v231, v229, s41
    v_perm_b32 v30, v235, v233, s41
    v_perm_b32 v31, v239, v237, s41
    s_nop 1
    v_mfma_f32_32x32x16_bf16 v[48:63], v[16:19], v[40:43], v[48:63]
    v_mfma_f32_32x32x16_bf16 v[64:79], v[20:23], v[40:43], v[64:79]
    v_mfma_f32_32x32x16_bf16 v[80:95], v[24:27], v[40:43], v[80:95]
    v_mfma_f32_32x32x16_bf16 v[96:111], v[28:31], v[40:43], v[96:111]
    v_perm_b32 v16, v242, v240, s40
    v_perm_b32 v17, v246, v244, s40
    v_perm_b32 v18, v250, v248, s40
    v_perm_b32 v19, v254, v252, s40
    v_perm_b32 v20, v242, v240, s41
    v_perm_b32 v21, v246, v244, s41
    v_perm_b32 v22, v250, v248, s41
    v_perm_b32 v23, v254, v252, s41
    v_perm_b32 v24, v243, v241, s40
    v_perm_b32 v25, v247, v245, s40
    v_perm_b32 v26, v251, v249, s40
    v_perm_b32 v27, v255, v253, s40
    v_perm_b32 v28, v243, v241, s41
    v_perm_b32 v29, v247, v245, s41
    v_perm_b32 v30, v251, v249, s41
    v_perm_b32 v31, v255, v253, s41
    s_nop 1
    v_mfma_f32_32x32x16_bf16 v[48:63], v[16:19], v[44:47], v[48:63]
    v_mfma_f32_32x32x16_bf16 v[64:79], v[20:23], v[44:47], v[64:79]
    v_mfma_f32_32x32x16_bf16 v[80:95], v[24:27], v[44:47], v[80:95]
    v_mfma_f32_32x32x16_bf16 v[96:111], v[28:31], v[44:47], v[96:111]
    s_nop 7
    s_nop 7
    s_waitcnt vmcnt(0)
    s_barrier
    v_lshlrev_b32 v9, 4, v2
    s_lshl_b32 s27, s5, 12
    v_add_u32 v10, s27, v9
    ds_write_b128 v10, v[48:51] offset:0
    ds_write_b128 v10, v[64:67] offset:1024
    ds_write_b128 v10, v[80:83] offset:2048
    ds_write_b128 v10, v[96:99] offset:3072
    ds_write_b128 v10, v[52:55] offset:16384
    ds_write_b128 v10, v[68:71] offset:17408
    ds_write_b128 v10, v[84:87] offset:18432
    ds_write_b128 v10, v[100:103] offset:19456
    ds_write_b128 v10, v[56:59] offset:32768
    ds_write_b128 v10, v[72:75] offset:33792
    ds_write_b128 v10, v[88:91] offset:34816
    ds_write_b128 v10, v[104:107] offset:35840
    ds_write_b128 v10, v[60:63] offset:49152
    ds_write_b128 v10, v[76:79] offset:50176
    ds_write_b128 v10, v[92:95] offset:51200
    ds_write_b128 v10, v[108:111] offset:52224
    s_waitcnt lgkmcnt(0)
    s_barrier
    s_lshl_b32 s27, s5, 14
    v_add_u32 v10, s27, v9
    ds_read_b128 v[128:131], v10 offset:0
    ds_read_b128 v[132:135], v10 offset:1024
    ds_read_b128 v[136:139], v10 offset:2048
    ds_read_b128 v[140:143], v10 offset:3072
    ds_read_b128 v[144:147], v10 offset:4096
    ds_read_b128 v[148:151], v10 offset:5120
    ds_read_b128 v[152:155], v10 offset:6144
    ds_read_b128 v[156:159], v10 offset:7168
    ds_read_b128 v[160:163], v10 offset:8192
    ds_read_b128 v[164:167], v10 offset:9216
    ds_read_b128 v[168:171], v10 offset:10240
    ds_read_b128 v[172:175], v10 offset:11264
    ds_read_b128 v[176:179], v10 offset:12288
    ds_read_b128 v[180:183], v10 offset:13312
    ds_read_b128 v[184:187], v10 offset:14336
    ds_read_b128 v[188:191], v10 offset:15360
    s_waitcnt lgkmcnt(0)
    v_add_f32 v48, v128, v144
    v_add_f32 v64, v160, v176
    v_add_f32 v49, v129, v145
    v_add_f32 v65, v161, v177
    v_add_f32 v50, v130, v146
    v_add_f32 v66, v162, v178
    v_add_f32 v51, v131, v147
    v_add_f32 v67, v163, v179
    v_add_f32 v52, v132, v148
    v_add_f32 v68, v164, v180
    v_add_f32 v53, v133, v149
    v_add_f32 v69, v165, v181
    v_add_f32 v54, v134, v150
    v_add_f32 v70, v166, v182
    v_add_f32 v55, v135, v151
    v_add_f32 v71, v167, v183
    v_add_f32 v56, v136, v152
    v_add_f32 v72, v168, v184
    v_add_f32 v57, v137, v153
    v_add_f32 v73, v169, v185
    v_add_f32 v58, v138, v154
    v_add_f32 v74, v170, v186
    v_add_f32 v59, v139, v155
    v_add_f32 v75, v171, v187
    v_add_f32 v60, v140, v156
    v_add_f32 v76, v172, v188
    v_add_f32 v61, v141, v157
    v_add_f32 v77, v173, v189
    v_add_f32 v62, v142, v158
    v_add_f32 v78, v174, v190
    v_add_f32 v63, v143, v159
    v_add_f32 v79, v175, v191
    v_add_f32 v48, v48, v64
    v_add_f32 v49, v49, v65
    v_add_f32 v50, v50, v66
    v_add_f32 v51, v51, v67
    v_add_f32 v52, v52, v68
    v_add_f32 v53, v53, v69
    v_add_f32 v54, v54, v70
    v_add_f32 v55, v55, v71
    v_add_f32 v56, v56, v72
    v_add_f32 v57, v57, v73
    v_add_f32 v58, v58, v74
    v_add_f32 v59, v59, v75
    v_add_f32 v60, v60, v76
    v_add_f32 v61, v61, v77
    v_add_f32 v62, v62, v78
    v_add_f32 v63, v63, v79
    v_add_u32 v8, s24, v3
    s_lshl_b32 s27, s4, 8
    s_lshl_b32 s28, s5, 6
    s_add_u32 s27, s27, s28
    v_lshlrev_b32 v9, 5, v4
    v_add_u32 v9, s27, v9
    v_mul_u32_u24 v10, 1024, v8
    v_add_u32 v10, v10, v9
    s_mov_b32 s28, s10
    s_mov_b32 s29, s11
    s_mov_b32 s30, 0x200000
    s_mov_b32 s31, 0x00020000
    buffer_load_dwordx4 v[24:27], v10, s[28:31], 0 offen
    buffer_load_dwordx4 v[28:31], v10, s[28:31], 0 offen offset:16
    s_waitcnt vmcnt(0)
    v_lshlrev_b32 v11, 16, v24
    v_add_f32 v48, v48, v11
    v_and_b32 v11, 0xffff0000, v24
    v_add_f32 v52, v52, v11
    v_lshlrev_b32 v11, 16, v25
    v_add_f32 v56, v56, v11
    v_and_b32 v11, 0xffff0000, v25
    v_add_f32 v60, v60, v11
    v_lshlrev_b32 v11, 16, v26
    v_add_f32 v49, v49, v11
    v_and_b32 v11, 0xffff0000, v26
    v_add_f32 v53, v53, v11
    v_lshlrev_b32 v11, 16, v27
    v_add_f32 v57, v57, v11
    v_and_b32 v11, 0xffff0000, v27
    v_add_f32 v61, v61, v11
    v_lshlrev_b32 v11, 16, v28
    v_add_f32 v50, v50, v11
    v_and_b32 v11, 0xffff0000, v28
    v_add_f32 v54, v54, v11
    v_lshlrev_b32 v11, 16, v29
    v_add_f32 v58, v58, v11
    v_and_b32 v11, 0xffff0000, v29
    v_add_f32 v62, v62, v11
    v_lshlrev_b32 v11, 16, v30
    v_add_f32 v51, v51, v11
    v_and_b32 v11, 0xffff0000, v30
    v_add_f32 v55, v55, v11
    v_lshlrev_b32 v11, 16, v31
    v_add_f32 v59, v59, v11
    v_and_b32 v11, 0xffff0000, v31
    v_add_f32 v63, v63, v11
    s_add_u32 s28, s6, 0x800000
    s_addc_u32 s29, s7, 0
    s_mov_b32 s30, 0x200000
    s_mov_b32 s31, 0x00020000
    v_cvt_pk_bf16_f32 v16, v48, v52
    v_cvt_pk_bf16_f32 v17, v56, v60
    v_cvt_pk_bf16_f32 v18, v49, v53
    v_cvt_pk_bf16_f32 v19, v57, v61
    v_cvt_pk_bf16_f32 v20, v50, v54
    v_cvt_pk_bf16_f32 v21, v58, v62
    v_cvt_pk_bf16_f32 v22, v51, v55
    v_cvt_pk_bf16_f32 v23, v59, v63
    buffer_store_dwordx4 v[16:19], v10, s[28:31], 0 offen
    buffer_store_dwordx4 v[20:23], v10, s[28:31], 0 offen offset:16
L_end_k3_kernel:
    s_endpgm
.section .rodata,"a"
.p2align 6
.amdhsa_kernel k3_kernel
  .amdhsa_next_free_vgpr 256
  .amdhsa_next_free_sgpr 96
  .amdhsa_accum_offset 256
  .amdhsa_group_segment_fixed_size 0
  .amdhsa_kernarg_size 88
  .amdhsa_user_sgpr_count 2
  .amdhsa_user_sgpr_kernarg_segment_ptr 1
  .amdhsa_system_sgpr_workgroup_id_x 1
.end_amdhsa_kernel
.text

.globl k4_kernel
.p2align 8
.type k4_kernel,@function
k4_kernel:
    s_and_b32 s3, s2, 63
    s_lshr_b32 s4, s2, 6
    s_cmp_ge_u32 s4, 4
    s_cbranch_scc1 L_end_k4_kernel
    s_load_dwordx2 s[6:7], s[0:1], 80
    s_load_dwordx2 s[8:9], s[0:1], 32
    s_load_dwordx2 s[10:11], s[0:1], 0
    s_load_dwordx2 s[12:13], s[0:1], 64
    v_lshrrev_b32 v1, 6, v0
    v_and_b32 v2, 63, v0
    v_and_b32 v3, 31, v2
    v_lshrrev_b32 v4, 5, v2
    v_readfirstlane_b32 s5, v1
    s_mov_b32 s40, 0x05040100
    s_mov_b32 s41, 0x07060302
    s_waitcnt lgkmcnt(0)
    s_add_u32 s16, s6, 0x800000
    s_addc_u32 s17, s7, 0
    s_mov_b32 s18, 0x200000
    s_mov_b32 s19, 0x00020000
    s_mov_b32 s20, s8
    s_mov_b32 s21, s9
    s_mov_b32 s22, 0x80000
    s_mov_b32 s23, 0x00020000
    s_lshl_b32 s24, s3, 5
    s_mul_i32 s25, s5, 8
    s_lshl_b32 s26, s4, 8
    s_mul_i32 s27, s25, 16384
    s_add_u32 s26, s26, s27
    v_mul_u32_u24 v5, 8192, v4
    v_lshl_add_u32 v5, v3, 3, v5
    v_lshrrev_b32 v6, 3, v0
    v_and_b32 v7, 7, v0
    v_add_u32 v8, s24, v6
    v_mul_u32_u24 v8, 1024, v8
    v_lshl_add_u32 v8, v7, 4, v8
    buffer_load_dwordx4 v[16:19], v8, s[16:19], 0 offen offset:0
    buffer_load_dwordx4 v[20:23], v8, s[16:19], 0 offen offset:128
    buffer_load_dwordx4 v[24:27], v8, s[16:19], 0 offen offset:256
    buffer_load_dwordx4 v[28:31], v8, s[16:19], 0 offen offset:384
    buffer_load_dwordx4 v[32:35], v8, s[16:19], 0 offen offset:512
    buffer_load_dwordx4 v[36:39], v8, s[16:19], 0 offen offset:640
    buffer_load_dwordx4 v[40:43], v8, s[16:19], 0 offen offset:768
    buffer_load_dwordx4 v[44:47], v8, s[16:19], 0 offen offset:896
    buffer_load_dwordx2 v[128:129], v5, s[20:23], s26 offen offset:0
    buffer_load_dwordx2 v[130:131], v5, s[20:23], s26 offen offset:1024
    buffer_load_dwordx2 v[132:133], v5, s[20:23], s26 offen offset:2048
    buffer_load_dwordx2 v[134:135], v5, s[20:23], s26 offen offset:3072
    s_add_u32 s28, s26, 0x1000
    buffer_load_dwordx2 v[136:137], v5, s[20:23], s28 offen
    s_add_u32 s28, s26, 0x1400
    buffer_load_dwordx2 v[138:139], v5, s[20:23], s28 offen
    s_add_u32 s28, s26, 0x1800
    buffer_load_dwordx2 v[140:141], v5, s[20:23], s28 offen
    s_add_u32 s28, s26, 0x1c00
    buffer_load_dwordx2 v[142:143], v5, s[20:23], s28 offen
    s_add_u32 s28, s26, 0x4000
    buffer_load_dwordx2 v[144:145], v5, s[20:23], s28 offen
    s_add_u32 s28, s26, 0x4400
    buffer_load_dwordx2 v[146:147], v5, s[20:23], s28 offen
    s_add_u32 s28, s26, 0x4800
    buffer_load_dwordx2 v[148:149], v5, s[20:23], s28 offen
    s_add_u32 s28, s26, 0x4c00
    buffer_load_dwordx2 v[150:151], v5, s[20:23], s28 offen
    s_add_u32 s28, s26, 0x5000
    buffer_load_dwordx2 v[152:153], v5, s[20:23], s28 offen
    s_add_u32 s28, s26, 0x5400
    buffer_load_dwordx2 v[154:155], v5, s[20:23], s28 offen
    s_add_u32 s28, s26, 0x5800
    buffer_load_dwordx2 v[156:157], v5, s[20:23], s28 offen
    s_add_u32 s28, s26, 0x5c00
    buffer_load_dwordx2 v[158:159], v5, s[20:23], s28 offen
    s_add_u32 s28, s26, 0x8000
    buffer_load_dwordx2 v[160:161], v5, s[20:23], s28 offen
    s_add_u32 s28, s26, 0x8400
    buffer_load_dwordx2 v[162:163], v5, s[20:23], s28 offen
    s_add_u32 s28, s26, 0x8800
    buffer_load_dwordx2 v[164:165], v5, s[20:23], s28 offen
    s_add_u32 s28, s26, 0x8c00
    buffer_load_dwordx2 v[166:167], v5, s[20:23], s28 offen
    s_add_u32 s28, s26, 0x9000
    buffer_load_dwordx2 v[168:169], v5, s[20:23], s28 offen
    s_add_u32 s28, s26, 0x9400
    buffer_load_dwordx2 v[170:171], v5, s[20:23], s28 offen
    s_add_u32 s28, s26, 0x9800
    buffer_load_dwordx2 v[172:173], v5, s[20:23], s28 offen
    s_add_u32 s28, s26, 0x9c00
    buffer_load_dwordx2 v[174:175], v5, s[20:23], s28 offen
    s_add_u32 s28, s26, 0xc000
    buffer_load_dwordx2 v[176:177], v5, s[20:23], s28 offen
    s_add_u32 s28, s26, 0xc400
    buffer_load_dwordx2 v[178:179], v5, s[20:23], s28 offen
    s_add_u32 s28, s26, 0xc800
    buffer_load_dwordx2 v[180:181], v5, s[20:23], s28 offen
    s_add_u32 s28, s26, 0xcc00
    buffer_load_dwordx2 v[182:183], v5, s[20:23], s28 offen
    s_add_u32 s28, s26, 0xd000
    buffer_load_dwordx2 v[184:185], v5, s[20:23], s28 offen
    s_add_u32 s28, s26, 0xd400
    buffer_load_dwordx2 v[186:187], v5, s[20:23], s28 offen
    s_add_u32 s28, s26, 0xd800
    buffer_load_dwordx2 v[188:189], v5, s[20:23], s28 offen
    s_add_u32 s28, s26, 0xdc00
    buffer_load_dwordx2 v[190:191], v5, s[20:23], s28 offen
    s_waitcnt vmcnt(32)
    s_add_u32 s28, s26, 0x10000
    buffer_load_dwordx2 v[192:193], v5, s[20:23], s28 offen
    s_add_u32 s28, s26, 0x10400
    buffer_load_dwordx2 v[194:195], v5, s[20:23], s28 offen
    s_add_u32 s28, s26, 0x10800
    buffer_load_dwordx2 v[196:197], v5, s[20:23], s28 offen
    s_add_u32 s28, s26, 0x10c00
    buffer_load_dwordx2 v[198:199], v5, s[20:23], s28 offen
    s_add_u32 s28, s26, 0x11000
    buffer_load_dwordx2 v[200:201], v5, s[20:23], s28 offen
    s_add_u32 s28, s26, 0x11400
    buffer_load_dwordx2 v[202:203], v5, s[20:23], s28 offen
    s_add_u32 s28, s26, 0x11800
    buffer_load_dwordx2 v[204:205], v5, s[20:23], s28 offen
    s_add_u32 s28, s26, 0x11c00
    buffer_load_dwordx2 v[206:207], v5, s[20:23], s28 offen
    s_add_u32 s28, s26, 0x14000
    buffer_load_dwordx2 v[208:209], v5, s[20:23], s28 offen
    s_add_u32 s28, s26, 0x14400
    buffer_load_dwordx2 v[210:211], v5, s[20:23], s28 offen
    s_add_u32 s28, s26, 0x14800
    buffer_load_dwordx2 v[212:213], v5, s[20:23], s28 offen
    s_add_u32 s28, s26, 0x14c00
    buffer_load_dwordx2 v[214:215], v5, s[20:23], s28 offen
    s_add_u32 s28, s26, 0x15000
    buffer_load_dwordx2 v[216:217], v5, s[20:23], s28 offen
    s_add_u32 s28, s26, 0x15400
    buffer_load_dwordx2 v[218:219], v5, s[20:23], s28 offen
    s_add_u32 s28, s26, 0x15800
    buffer_load_dwordx2 v[220:221], v5, s[20:23], s28 offen
    s_add_u32 s28, s26, 0x15c00
    buffer_load_dwordx2 v[222:223], v5, s[20:23], s28 offen
    s_add_u32 s28, s26, 0x18000
    buffer_load_dwordx2 v[224:225], v5, s[20:23], s28 offen
    s_add_u32 s28, s26, 0x18400
    buffer_load_dwordx2 v[226:227], v5, s[20:23], s28 offen
    s_add_u32 s28, s26, 0x18800
    buffer_load_dwordx2 v[228:229], v5, s[20:23], s28 offen
    s_add_u32 s28, s26, 0x18c00
    buffer_load_dwordx2 v[230:231], v5, s[20:23], s28 offen
    s_add_u32 s28, s26, 0x19000
    buffer_load_dwordx2 v[232:233], v5, s[20:23], s28 offen
    s_add_u32 s28, s26, 0x19400
    buffer_load_dwordx2 v[234:235], v5, s[20:23], s28 offen
    s_add_u32 s28, s26, 0x19800
    buffer_load_dwordx2 v[236:237], v5, s[20:23], s28 offen
    s_add_u32 s28, s26, 0x19c00
    buffer_load_dwordx2 v[238:239], v5, s[20:23], s28 offen
    s_add_u32 s28, s26, 0x1c000
    buffer_load_dwordx2 v[240:241], v5, s[20:23], s28 offen
    s_add_u32 s28, s26, 0x1c400
    buffer_load_dwordx2 v[242:243], v5, s[20:23], s28 offen
    s_add_u32 s28, s26, 0x1c800
    buffer_load_dwordx2 v[244:245], v5, s[20:23], s28 offen
    s_add_u32 s28, s26, 0x1cc00
    buffer_load_dwordx2 v[246:247], v5, s[20:23], s28 offen
    s_add_u32 s28, s26, 0x1d000
    buffer_load_dwordx2 v[248:249], v5, s[20:23], s28 offen
    s_add_u32 s28, s26, 0x1d400
    buffer_load_dwordx2 v[250:251], v5, s[20:23], s28 offen
    s_add_u32 s28, s26, 0x1d800
    buffer_load_dwordx2 v[252:253], v5, s[20:23], s28 offen
    s_add_u32 s28, s26, 0x1dc00
    buffer_load_dwordx2 v[254:255], v5, s[20:23], s28 offen
    v_lshlrev_b32 v48, 16, v16
    v_and_b32 v49, 0xffff0000, v16
    v_lshlrev_b32 v50, 16, v17
    v_and_b32 v51, 0xffff0000, v17
    v_lshlrev_b32 v52, 16, v18
    v_and_b32 v53, 0xffff0000, v18
    v_lshlrev_b32 v54, 16, v19
    v_and_b32 v55, 0xffff0000, v19
    v_lshlrev_b32 v56, 16, v20
    v_and_b32 v57, 0xffff0000, v20
    v_lshlrev_b32 v58, 16, v21
    v_and_b32 v59, 0xffff0000, v21
    v_lshlrev_b32 v60, 16, v22
    v_and_b32 v61, 0xffff0000, v22
    v_lshlrev_b32 v62, 16, v23
    v_and_b32 v63, 0xffff0000, v23
    v_lshlrev_b32 v64, 16, v24
    v_and_b32 v65, 0xffff0000, v24
    v_lshlrev_b32 v66, 16, v25
    v_and_b32 v67, 0xffff0000, v25
    v_lshlrev_b32 v68, 16, v26
    v_and_b32 v69, 0xffff0000, v26
    v_lshlrev_b32 v70, 16, v27
    v_and_b32 v71, 0xffff0000, v27
    v_lshlrev_b32 v72, 16, v28
    v_and_b32 v73, 0xffff0000, v28
    v_lshlrev_b32 v74, 16, v29
    v_and_b32 v75, 0xffff0000, v29
    v_lshlrev_b32 v76, 16, v30
    v_and_b32 v77, 0xffff0000, v30
    v_lshlrev_b32 v78, 16, v31
    v_and_b32 v79, 0xffff0000, v31
    v_lshlrev_b32 v80, 16, v32
    v_and_b32 v81, 0xffff0000, v32
    v_lshlrev_b32 v82, 16, v33
    v_and_b32 v83, 0xffff0000, v33
    v_lshlrev_b32 v84, 16, v34
    v_and_b32 v85, 0xffff0000, v34
    v_lshlrev_b32 v86, 16, v35
    v_and_b32 v87, 0xffff0000, v35
    v_lshlrev_b32 v88, 16, v36
    v_and_b32 v89, 0xffff0000, v36
    v_lshlrev_b32 v90, 16, v37
    v_and_b32 v91, 0xffff0000, v37
    v_lshlrev_b32 v92, 16, v38
    v_and_b32 v93, 0xffff0000, v38
    v_lshlrev_b32 v94, 16, v39
    v_and_b32 v95, 0xffff0000, v39
    v_lshlrev_b32 v96, 16, v40
    v_and_b32 v97, 0xffff0000, v40
    v_lshlrev_b32 v98, 16, v41
    v_and_b32 v99, 0xffff0000, v41
    v_lshlrev_b32 v100, 16, v42
    v_and_b32 v101, 0xffff0000, v42
    v_lshlrev_b32 v102, 16, v43
    v_and_b32 v103, 0xffff0000, v43
    v_lshlrev_b32 v104, 16, v44
    v_and_b32 v105, 0xffff0000, v44
    v_lshlrev_b32 v106, 16, v45
    v_and_b32 v107, 0xffff0000, v45
    v_lshlrev_b32 v108, 16, v46
    v_and_b32 v109, 0xffff0000, v46
    v_lshlrev_b32 v110, 16, v47
    v_and_b32 v111, 0xffff0000, v47
    v_add_f32 v9, v48, v49
    v_add_f32 v9, v9, v50
    v_add_f32 v9, v9, v51
    v_add_f32 v9, v9, v52
    v_add_f32 v9, v9, v53
    v_add_f32 v9, v9, v54
    v_add_f32 v9, v9, v55
    v_add_f32 v9, v9, v56
    v_add_f32 v9, v9, v57
    v_add_f32 v9, v9, v58
    v_add_f32 v9, v9, v59
    v_add_f32 v9, v9, v60
    v_add_f32 v9, v9, v61
    v_add_f32 v9, v9, v62
    v_add_f32 v9, v9, v63
    v_add_f32 v9, v9, v64
    v_add_f32 v9, v9, v65
    v_add_f32 v9, v9, v66
    v_add_f32 v9, v9, v67
    v_add_f32 v9, v9, v68
    v_add_f32 v9, v9, v69
    v_add_f32 v9, v9, v70
    v_add_f32 v9, v9, v71
    v_add_f32 v9, v9, v72
    v_add_f32 v9, v9, v73
    v_add_f32 v9, v9, v74
    v_add_f32 v9, v9, v75
    v_add_f32 v9, v9, v76
    v_add_f32 v9, v9, v77
    v_add_f32 v9, v9, v78
    v_add_f32 v9, v9, v79
    v_add_f32 v9, v9, v80
    v_add_f32 v9, v9, v81
    v_add_f32 v9, v9, v82
    v_add_f32 v9, v9, v83
    v_add_f32 v9, v9, v84
    v_add_f32 v9, v9, v85
    v_add_f32 v9, v9, v86
    v_add_f32 v9, v9, v87
    v_add_f32 v9, v9, v88
    v_add_f32 v9, v9, v89
    v_add_f32 v9, v9, v90
    v_add_f32 v9, v9, v91
    v_add_f32 v9, v9, v92
    v_add_f32 v9, v9, v93
    v_add_f32 v9, v9, v94
    v_add_f32 v9, v9, v95
    v_add_f32 v9, v9, v96
    v_add_f32 v9, v9, v97
    v_add_f32 v9, v9, v98
    v_add_f32 v9, v9, v99
    v_add_f32 v9, v9, v100
    v_add_f32 v9, v9, v101
    v_add_f32 v9, v9, v102
    v_add_f32 v9, v9, v103
    v_add_f32 v9, v9, v104
    v_add_f32 v9, v9, v105
    v_add_f32 v9, v9, v106
    v_add_f32 v9, v9, v107
    v_add_f32 v9, v9, v108
    v_add_f32 v9, v9, v109
    v_add_f32 v9, v9, v110
    v_add_f32 v9, v9, v111
    s_nop 1
    v_add_f32_dpp v9, v9, v9 quad_perm:[1,0,3,2] row_mask:0xf bank_mask:0xf
    s_nop 1
    v_add_f32_dpp v9, v9, v9 quad_perm:[2,3,0,1] row_mask:0xf bank_mask:0xf
    s_nop 1
    v_add_f32_dpp v9, v9, v9 row_half_mirror row_mask:0xf bank_mask:0xf
    v_mul_f32 v9, 0x3b000000, v9
    v_sub_f32 v48, v48, v9
    v_sub_f32 v49, v49, v9
    v_sub_f32 v50, v50, v9
    v_sub_f32 v51, v51, v9
    v_sub_f32 v52, v52, v9
    v_sub_f32 v53, v53, v9
    v_sub_f32 v54, v54, v9
    v_sub_f32 v55, v55, v9
    v_sub_f32 v56, v56, v9
    v_sub_f32 v57, v57, v9
    v_sub_f32 v58, v58, v9
    v_sub_f32 v59, v59, v9
    v_sub_f32 v60, v60, v9
    v_sub_f32 v61, v61, v9
    v_sub_f32 v62, v62, v9
    v_sub_f32 v63, v63, v9
    v_sub_f32 v64, v64, v9
    v_sub_f32 v65, v65, v9
    v_sub_f32 v66, v66, v9
    v_sub_f32 v67, v67, v9
    v_sub_f32 v68, v68, v9
    v_sub_f32 v69, v69, v9
    v_sub_f32 v70, v70, v9
    v_sub_f32 v71, v71, v9
    v_sub_f32 v72, v72, v9
    v_sub_f32 v73, v73, v9
    v_sub_f32 v74, v74, v9
    v_sub_f32 v75, v75, v9
    v_sub_f32 v76, v76, v9
    v_sub_f32 v77, v77, v9
    v_sub_f32 v78, v78, v9
    v_sub_f32 v79, v79, v9
    v_sub_f32 v80, v80, v9
    v_sub_f32 v81, v81, v9
    v_sub_f32 v82, v82, v9
    v_sub_f32 v83, v83, v9
    v_sub_f32 v84, v84, v9
    v_sub_f32 v85, v85, v9
    v_sub_f32 v86, v86, v9
    v_sub_f32 v87, v87, v9
    v_sub_f32 v88, v88, v9
    v_sub_f32 v89, v89, v9
    v_sub_f32 v90, v90, v9
    v_sub_f32 v91, v91, v9
    v_sub_f32 v92, v92, v9
    v_sub_f32 v93, v93, v9
    v_sub_f32 v94, v94, v9
    v_sub_f32 v95, v95, v9
    v_sub_f32 v96, v96, v9
    v_sub_f32 v97, v97, v9
    v_sub_f32 v98, v98, v9
    v_sub_f32 v99, v99, v9
    v_sub_f32 v100, v100, v9
    v_sub_f32 v101, v101, v9
    v_sub_f32 v102, v102, v9
    v_sub_f32 v103, v103, v9
    v_sub_f32 v104, v104, v9
    v_sub_f32 v105, v105, v9
    v_sub_f32 v106, v106, v9
    v_sub_f32 v107, v107, v9
    v_sub_f32 v108, v108, v9
    v_sub_f32 v109, v109, v9
    v_sub_f32 v110, v110, v9
    v_sub_f32 v111, v111, v9
    v_mul_f32 v10, v48, v48
    v_fmac_f32 v10, v49, v49
    v_fmac_f32 v10, v50, v50
    v_fmac_f32 v10, v51, v51
    v_fmac_f32 v10, v52, v52
    v_fmac_f32 v10, v53, v53
    v_fmac_f32 v10, v54, v54
    v_fmac_f32 v10, v55, v55
    v_fmac_f32 v10, v56, v56
    v_fmac_f32 v10, v57, v57
    v_fmac_f32 v10, v58, v58
    v_fmac_f32 v10, v59, v59
    v_fmac_f32 v10, v60, v60
    v_fmac_f32 v10, v61, v61
    v_fmac_f32 v10, v62, v62
    v_fmac_f32 v10, v63, v63
    v_fmac_f32 v10, v64, v64
    v_fmac_f32 v10, v65, v65
    v_fmac_f32 v10, v66, v66
    v_fmac_f32 v10, v67, v67
    v_fmac_f32 v10, v68, v68
    v_fmac_f32 v10, v69, v69
    v_fmac_f32 v10, v70, v70
    v_fmac_f32 v10, v71, v71
    v_fmac_f32 v10, v72, v72
    v_fmac_f32 v10, v73, v73
    v_fmac_f32 v10, v74, v74
    v_fmac_f32 v10, v75, v75
    v_fmac_f32 v10, v76, v76
    v_fmac_f32 v10, v77, v77
    v_fmac_f32 v10, v78, v78
    v_fmac_f32 v10, v79, v79
    v_fmac_f32 v10, v80, v80
    v_fmac_f32 v10, v81, v81
    v_fmac_f32 v10, v82, v82
    v_fmac_f32 v10, v83, v83
    v_fmac_f32 v10, v84, v84
    v_fmac_f32 v10, v85, v85
    v_fmac_f32 v10, v86, v86
    v_fmac_f32 v10, v87, v87
    v_fmac_f32 v10, v88, v88
    v_fmac_f32 v10, v89, v89
    v_fmac_f32 v10, v90, v90
    v_fmac_f32 v10, v91, v91
    v_fmac_f32 v10, v92, v92
    v_fmac_f32 v10, v93, v93
    v_fmac_f32 v10, v94, v94
    v_fmac_f32 v10, v95, v95
    v_fmac_f32 v10, v96, v96
    v_fmac_f32 v10, v97, v97
    v_fmac_f32 v10, v98, v98
    v_fmac_f32 v10, v99, v99
    v_fmac_f32 v10, v100, v100
    v_fmac_f32 v10, v101, v101
    v_fmac_f32 v10, v102, v102
    v_fmac_f32 v10, v103, v103
    v_fmac_f32 v10, v104, v104
    v_fmac_f32 v10, v105, v105
    v_fmac_f32 v10, v106, v106
    v_fmac_f32 v10, v107, v107
    v_fmac_f32 v10, v108, v108
    v_fmac_f32 v10, v109, v109
    v_fmac_f32 v10, v110, v110
    v_fmac_f32 v10, v111, v111
    s_nop 1
    v_add_f32_dpp v10, v10, v10 quad_perm:[1,0,3,2] row_mask:0xf bank_mask:0xf
    s_nop 1
    v_add_f32_dpp v10, v10, v10 quad_perm:[2,3,0,1] row_mask:0xf bank_mask:0xf
    s_nop 1
    v_add_f32_dpp v10, v10, v10 row_half_mirror row_mask:0xf bank_mask:0xf
    v_mov_b32 v11, 0x3727c5ac
    v_fmac_f32 v11, 0x3b000000, v10
    v_rsq_f32 v11, v11
    s_nop 0
    v_mul_f32 v48, v48, v11
    v_mul_f32 v49, v49, v11
    v_mul_f32 v50, v50, v11
    v_mul_f32 v51, v51, v11
    v_mul_f32 v52, v52, v11
    v_mul_f32 v53, v53, v11
    v_mul_f32 v54, v54, v11
    v_mul_f32 v55, v55, v11
    v_mul_f32 v56, v56, v11
    v_mul_f32 v57, v57, v11
    v_mul_f32 v58, v58, v11
    v_mul_f32 v59, v59, v11
    v_mul_f32 v60, v60, v11
    v_mul_f32 v61, v61, v11
    v_mul_f32 v62, v62, v11
    v_mul_f32 v63, v63, v11
    v_mul_f32 v64, v64, v11
    v_mul_f32 v65, v65, v11
    v_mul_f32 v66, v66, v11
    v_mul_f32 v67, v67, v11
    v_mul_f32 v68, v68, v11
    v_mul_f32 v69, v69, v11
    v_mul_f32 v70, v70, v11
    v_mul_f32 v71, v71, v11
    v_mul_f32 v72, v72, v11
    v_mul_f32 v73, v73, v11
    v_mul_f32 v74, v74, v11
    v_mul_f32 v75, v75, v11
    v_mul_f32 v76, v76, v11
    v_mul_f32 v77, v77, v11
    v_mul_f32 v78, v78, v11
    v_mul_f32 v79, v79, v11
    v_mul_f32 v80, v80, v11
    v_mul_f32 v81, v81, v11
    v_mul_f32 v82, v82, v11
    v_mul_f32 v83, v83, v11
    v_mul_f32 v84, v84, v11
    v_mul_f32 v85, v85, v11
    v_mul_f32 v86, v86, v11
    v_mul_f32 v87, v87, v11
    v_mul_f32 v88, v88, v11
    v_mul_f32 v89, v89, v11
    v_mul_f32 v90, v90, v11
    v_mul_f32 v91, v91, v11
    v_mul_f32 v92, v92, v11
    v_mul_f32 v93, v93, v11
    v_mul_f32 v94, v94, v11
    v_mul_f32 v95, v95, v11
    v_mul_f32 v96, v96, v11
    v_mul_f32 v97, v97, v11
    v_mul_f32 v98, v98, v11
    v_mul_f32 v99, v99, v11
    v_mul_f32 v100, v100, v11
    v_mul_f32 v101, v101, v11
    v_mul_f32 v102, v102, v11
    v_mul_f32 v103, v103, v11
    v_mul_f32 v104, v104, v11
    v_mul_f32 v105, v105, v11
    v_mul_f32 v106, v106, v11
    v_mul_f32 v107, v107, v11
    v_mul_f32 v108, v108, v11
    v_mul_f32 v109, v109, v11
    v_mul_f32 v110, v110, v11
    v_mul_f32 v111, v111, v11
    v_cvt_pk_bf16_f32 v16, v48, v49
    v_cvt_pk_bf16_f32 v17, v50, v51
    v_cvt_pk_bf16_f32 v18, v52, v53
    v_cvt_pk_bf16_f32 v19, v54, v55
    v_cvt_pk_bf16_f32 v20, v56, v57
    v_cvt_pk_bf16_f32 v21, v58, v59
    v_cvt_pk_bf16_f32 v22, v60, v61
    v_cvt_pk_bf16_f32 v23, v62, v63
    v_cvt_pk_bf16_f32 v24, v64, v65
    v_cvt_pk_bf16_f32 v25, v66, v67
    v_cvt_pk_bf16_f32 v26, v68, v69
    v_cvt_pk_bf16_f32 v27, v70, v71
    v_cvt_pk_bf16_f32 v28, v72, v73
    v_cvt_pk_bf16_f32 v29, v74, v75
    v_cvt_pk_bf16_f32 v30, v76, v77
    v_cvt_pk_bf16_f32 v31, v78, v79
    v_cvt_pk_bf16_f32 v32, v80, v81
    v_cvt_pk_bf16_f32 v33, v82, v83
    v_cvt_pk_bf16_f32 v34, v84, v85
    v_cvt_pk_bf16_f32 v35, v86, v87
    v_cvt_pk_bf16_f32 v36, v88, v89
    v_cvt_pk_bf16_f32 v37, v90, v91
    v_cvt_pk_bf16_f32 v38, v92, v93
    v_cvt_pk_bf16_f32 v39, v94, v95
    v_cvt_pk_bf16_f32 v40, v96, v97
    v_cvt_pk_bf16_f32 v41, v98, v99
    v_cvt_pk_bf16_f32 v42, v100, v101
    v_cvt_pk_bf16_f32 v43, v102, v103
    v_cvt_pk_bf16_f32 v44, v104, v105
    v_cvt_pk_bf16_f32 v45, v106, v107
    v_cvt_pk_bf16_f32 v46, v108, v109
    v_cvt_pk_bf16_f32 v47, v110, v111
    s_cmp_lg_u32 s4, 0
    s_cbranch_scc1 L_noxb_k4_kernel
    s_add_u32 s28, s6, 0xa00000
    s_addc_u32 s29, s7, 0
    s_mov_b32 s30, 0x200000
    s_mov_b32 s31, 0x00020000
    buffer_store_dwordx4 v[16:19], v8, s[28:31], 0 offen offset:0
    buffer_store_dwordx4 v[20:23], v8, s[28:31], 0 offen offset:128
    buffer_store_dwordx4 v[24:27], v8, s[28:31], 0 offen offset:256
    buffer_store_dwordx4 v[28:31], v8, s[28:31], 0 offen offset:384
    buffer_store_dwordx4 v[32:35], v8, s[28:31], 0 offen offset:512
    buffer_store_dwordx4 v[36:39], v8, s[28:31], 0 offen offset:640
    buffer_store_dwordx4 v[40:43], v8, s[28:31], 0 offen offset:768
    buffer_store_dwordx4 v[44:47], v8, s[28:31], 0 offen offset:896
L_noxb_k4_kernel:
    v_lshlrev_b32 v48, 16, v16
    v_and_b32 v49, 0xffff0000, v16
    v_lshlrev_b32 v50, 16, v17
    v_and_b32 v51, 0xffff0000, v17
    v_lshlrev_b32 v52, 16, v18
    v_and_b32 v53, 0xffff0000, v18
    v_lshlrev_b32 v54, 16, v19
    v_and_b32 v55, 0xffff0000, v19
    v_lshlrev_b32 v56, 16, v20
    v_and_b32 v57, 0xffff0000, v20
    v_lshlrev_b32 v58, 16, v21
    v_and_b32 v59, 0xffff0000, v21
    v_lshlrev_b32 v60, 16, v22
    v_and_b32 v61, 0xffff0000, v22
    v_lshlrev_b32 v62, 16, v23
    v_and_b32 v63, 0xffff0000, v23
    v_lshlrev_b32 v64, 16, v24
    v_and_b32 v65, 0xffff0000, v24
    v_lshlrev_b32 v66, 16, v25
    v_and_b32 v67, 0xffff0000, v25
    v_lshlrev_b32 v68, 16, v26
    v_and_b32 v69, 0xffff0000, v26
    v_lshlrev_b32 v70, 16, v27
    v_and_b32 v71, 0xffff0000, v27
    v_lshlrev_b32 v72, 16, v28
    v_and_b32 v73, 0xffff0000, v28
    v_lshlrev_b32 v74, 16, v29
    v_and_b32 v75, 0xffff0000, v29
    v_lshlrev_b32 v76, 16, v30
    v_and_b32 v77, 0xffff0000, v30
    v_lshlrev_b32 v78, 16, v31
    v_and_b32 v79, 0xffff0000, v31
    v_lshlrev_b32 v80, 16, v32
    v_and_b32 v81, 0xffff0000, v32
    v_lshlrev_b32 v82, 16, v33
    v_and_b32 v83, 0xffff0000, v33
    v_lshlrev_b32 v84, 16, v34
    v_and_b32 v85, 0xffff0000, v34
    v_lshlrev_b32 v86, 16, v35
    v_and_b32 v87, 0xffff0000, v35
    v_lshlrev_b32 v88, 16, v36
    v_and_b32 v89, 0xffff0000, v36
    v_lshlrev_b32 v90, 16, v37
    v_and_b32 v91, 0xffff0000, v37
    v_lshlrev_b32 v92, 16, v38
    v_and_b32 v93, 0xffff0000, v38
    v_lshlrev_b32 v94, 16, v39
    v_and_b32 v95, 0xffff0000, v39
    v_lshlrev_b32 v96, 16, v40
    v_and_b32 v97, 0xffff0000, v40
    v_lshlrev_b32 v98, 16, v41
    v_and_b32 v99, 0xffff0000, v41
    v_lshlrev_b32 v100, 16, v42
    v_and_b32 v101, 0xffff0000, v42
    v_lshlrev_b32 v102, 16, v43
    v_and_b32 v103, 0xffff0000, v43
    v_lshlrev_b32 v104, 16, v44
    v_and_b32 v105, 0xffff0000, v44
    v_lshlrev_b32 v106, 16, v45
    v_and_b32 v107, 0xffff0000, v45
    v_lshlrev_b32 v108, 16, v46
    v_and_b32 v109, 0xffff0000, v46
    v_lshlrev_b32 v110, 16, v47
    v_and_b32 v111, 0xffff0000, v47
    v_add_f32 v9, v48, v49
    v_add_f32 v9, v9, v50
    v_add_f32 v9, v9, v51
    v_add_f32 v9, v9, v52
    v_add_f32 v9, v9, v53
    v_add_f32 v9, v9, v54
    v_add_f32 v9, v9, v55
    v_add_f32 v9, v9, v56
    v_add_f32 v9, v9, v57
    v_add_f32 v9, v9, v58
    v_add_f32 v9, v9, v59
    v_add_f32 v9, v9, v60
    v_add_f32 v9, v9, v61
    v_add_f32 v9, v9, v62
    v_add_f32 v9, v9, v63
    v_add_f32 v9, v9, v64
    v_add_f32 v9, v9, v65
    v_add_f32 v9, v9, v66
    v_add_f32 v9, v9, v67
    v_add_f32 v9, v9, v68
    v_add_f32 v9, v9, v69
    v_add_f32 v9, v9, v70
    v_add_f32 v9, v9, v71
    v_add_f32 v9, v9, v72
    v_add_f32 v9, v9, v73
    v_add_f32 v9, v9, v74
    v_add_f32 v9, v9, v75
    v_add_f32 v9, v9, v76
    v_add_f32 v9, v9, v77
    v_add_f32 v9, v9, v78
    v_add_f32 v9, v9, v79
    v_add_f32 v9, v9, v80
    v_add_f32 v9, v9, v81
    v_add_f32 v9, v9, v82
    v_add_f32 v9, v9, v83
    v_add_f32 v9, v9, v84
    v_add_f32 v9, v9, v85
    v_add_f32 v9, v9, v86
    v_add_f32 v9, v9, v87
    v_add_f32 v9, v9, v88
    v_add_f32 v9, v9, v89
    v_add_f32 v9, v9, v90
    v_add_f32 v9, v9, v91
    v_add_f32 v9, v9, v92
    v_add_f32 v9, v9, v93
    v_add_f32 v9, v9, v94
    v_add_f32 v9, v9, v95
    v_add_f32 v9, v9, v96
    v_add_f32 v9, v9, v97
    v_add_f32 v9, v9, v98
    v_add_f32 v9, v9, v99
    v_add_f32 v9, v9, v100
    v_add_f32 v9, v9, v101
    v_add_f32 v9, v9, v102
    v_add_f32 v9, v9, v103
    v_add_f32 v9, v9, v104
    v_add_f32 v9, v9, v105
    v_add_f32 v9, v9, v106
    v_add_f32 v9, v9, v107
    v_add_f32 v9, v9, v108
    v_add_f32 v9, v9, v109
    v_add_f32 v9, v9, v110
    v_add_f32 v9, v9, v111
    s_nop 1
    v_add_f32_dpp v9, v9, v9 quad_perm:[1,0,3,2] row_mask:0xf bank_mask:0xf
    s_nop 1
    v_add_f32_dpp v9, v9, v9 quad_perm:[2,3,0,1] row_mask:0xf bank_mask:0xf
    s_nop 1
    v_add_f32_dpp v9, v9, v9 row_half_mirror row_mask:0xf bank_mask:0xf
    v_mul_f32 v9, 0x3b000000, v9
    v_sub_f32 v48, v48, v9
    v_sub_f32 v49, v49, v9
    v_sub_f32 v50, v50, v9
    v_sub_f32 v51, v51, v9
    v_sub_f32 v52, v52, v9
    v_sub_f32 v53, v53, v9
    v_sub_f32 v54, v54, v9
    v_sub_f32 v55, v55, v9
    v_sub_f32 v56, v56, v9
    v_sub_f32 v57, v57, v9
    v_sub_f32 v58, v58, v9
    v_sub_f32 v59, v59, v9
    v_sub_f32 v60, v60, v9
    v_sub_f32 v61, v61, v9
    v_sub_f32 v62, v62, v9
    v_sub_f32 v63, v63, v9
    v_sub_f32 v64, v64, v9
    v_sub_f32 v65, v65, v9
    v_sub_f32 v66, v66, v9
    v_sub_f32 v67, v67, v9
    v_sub_f32 v68, v68, v9
    v_sub_f32 v69, v69, v9
    v_sub_f32 v70, v70, v9
    v_sub_f32 v71, v71, v9
    v_sub_f32 v72, v72, v9
    v_sub_f32 v73, v73, v9
    v_sub_f32 v74, v74, v9
    v_sub_f32 v75, v75, v9
    v_sub_f32 v76, v76, v9
    v_sub_f32 v77, v77, v9
    v_sub_f32 v78, v78, v9
    v_sub_f32 v79, v79, v9
    v_sub_f32 v80, v80, v9
    v_sub_f32 v81, v81, v9
    v_sub_f32 v82, v82, v9
    v_sub_f32 v83, v83, v9
    v_sub_f32 v84, v84, v9
    v_sub_f32 v85, v85, v9
    v_sub_f32 v86, v86, v9
    v_sub_f32 v87, v87, v9
    v_sub_f32 v88, v88, v9
    v_sub_f32 v89, v89, v9
    v_sub_f32 v90, v90, v9
    v_sub_f32 v91, v91, v9
    v_sub_f32 v92, v92, v9
    v_sub_f32 v93, v93, v9
    v_sub_f32 v94, v94, v9
    v_sub_f32 v95, v95, v9
    v_sub_f32 v96, v96, v9
    v_sub_f32 v97, v97, v9
    v_sub_f32 v98, v98, v9
    v_sub_f32 v99, v99, v9
    v_sub_f32 v100, v100, v9
    v_sub_f32 v101, v101, v9
    v_sub_f32 v102, v102, v9
    v_sub_f32 v103, v103, v9
    v_sub_f32 v104, v104, v9
    v_sub_f32 v105, v105, v9
    v_sub_f32 v106, v106, v9
    v_sub_f32 v107, v107, v9
    v_sub_f32 v108, v108, v9
    v_sub_f32 v109, v109, v9
    v_sub_f32 v110, v110, v9
    v_sub_f32 v111, v111, v9
    v_mul_f32 v10, v48, v48
    v_fmac_f32 v10, v49, v49
    v_fmac_f32 v10, v50, v50
    v_fmac_f32 v10, v51, v51
    v_fmac_f32 v10, v52, v52
    v_fmac_f32 v10, v53, v53
    v_fmac_f32 v10, v54, v54
    v_fmac_f32 v10, v55, v55
    v_fmac_f32 v10, v56, v56
    v_fmac_f32 v10, v57, v57
    v_fmac_f32 v10, v58, v58
    v_fmac_f32 v10, v59, v59
    v_fmac_f32 v10, v60, v60
    v_fmac_f32 v10, v61, v61
    v_fmac_f32 v10, v62, v62
    v_fmac_f32 v10, v63, v63
    v_fmac_f32 v10, v64, v64
    v_fmac_f32 v10, v65, v65
    v_fmac_f32 v10, v66, v66
    v_fmac_f32 v10, v67, v67
    v_fmac_f32 v10, v68, v68
    v_fmac_f32 v10, v69, v69
    v_fmac_f32 v10, v70, v70
    v_fmac_f32 v10, v71, v71
    v_fmac_f32 v10, v72, v72
    v_fmac_f32 v10, v73, v73
    v_fmac_f32 v10, v74, v74
    v_fmac_f32 v10, v75, v75
    v_fmac_f32 v10, v76, v76
    v_fmac_f32 v10, v77, v77
    v_fmac_f32 v10, v78, v78
    v_fmac_f32 v10, v79, v79
    v_fmac_f32 v10, v80, v80
    v_fmac_f32 v10, v81, v81
    v_fmac_f32 v10, v82, v82
    v_fmac_f32 v10, v83, v83
    v_fmac_f32 v10, v84, v84
    v_fmac_f32 v10, v85, v85
    v_fmac_f32 v10, v86, v86
    v_fmac_f32 v10, v87, v87
    v_fmac_f32 v10, v88, v88
    v_fmac_f32 v10, v89, v89
    v_fmac_f32 v10, v90, v90
    v_fmac_f32 v10, v91, v91
    v_fmac_f32 v10, v92, v92
    v_fmac_f32 v10, v93, v93
    v_fmac_f32 v10, v94, v94
    v_fmac_f32 v10, v95, v95
    v_fmac_f32 v10, v96, v96
    v_fmac_f32 v10, v97, v97
    v_fmac_f32 v10, v98, v98
    v_fmac_f32 v10, v99, v99
    v_fmac_f32 v10, v100, v100
    v_fmac_f32 v10, v101, v101
    v_fmac_f32 v10, v102, v102
    v_fmac_f32 v10, v103, v103
    v_fmac_f32 v10, v104, v104
    v_fmac_f32 v10, v105, v105
    v_fmac_f32 v10, v106, v106
    v_fmac_f32 v10, v107, v107
    v_fmac_f32 v10, v108, v108
    v_fmac_f32 v10, v109, v109
    v_fmac_f32 v10, v110, v110
    v_fmac_f32 v10, v111, v111
    s_nop 1
    v_add_f32_dpp v10, v10, v10 quad_perm:[1,0,3,2] row_mask:0xf bank_mask:0xf
    s_nop 1
    v_add_f32_dpp v10, v10, v10 quad_perm:[2,3,0,1] row_mask:0xf bank_mask:0xf
    s_nop 1
    v_add_f32_dpp v10, v10, v10 row_half_mirror row_mask:0xf bank_mask:0xf
    v_mov_b32 v11, 0x3727c5ac
    v_fmac_f32 v11, 0x3b000000, v10
    v_rsq_f32 v11, v11
    s_nop 0
    v_mul_f32 v48, v48, v11
    v_mul_f32 v49, v49, v11
    v_mul_f32 v50, v50, v11
    v_mul_f32 v51, v51, v11
    v_mul_f32 v52, v52, v11
    v_mul_f32 v53, v53, v11
    v_mul_f32 v54, v54, v11
    v_mul_f32 v55, v55, v11
    v_mul_f32 v56, v56, v11
    v_mul_f32 v57, v57, v11
    v_mul_f32 v58, v58, v11
    v_mul_f32 v59, v59, v11
    v_mul_f32 v60, v60, v11
    v_mul_f32 v61, v61, v11
    v_mul_f32 v62, v62, v11
    v_mul_f32 v63, v63, v11
    v_mul_f32 v64, v64, v11
    v_mul_f32 v65, v65, v11
    v_mul_f32 v66, v66, v11
    v_mul_f32 v67, v67, v11
    v_mul_f32 v68, v68, v11
    v_mul_f32 v69, v69, v11
    v_mul_f32 v70, v70, v11
    v_mul_f32 v71, v71, v11
    v_mul_f32 v72, v72, v11
    v_mul_f32 v73, v73, v11
    v_mul_f32 v74, v74, v11
    v_mul_f32 v75, v75, v11
    v_mul_f32 v76, v76, v11
    v_mul_f32 v77, v77, v11
    v_mul_f32 v78, v78, v11
    v_mul_f32 v79, v79, v11
    v_mul_f32 v80, v80, v11
    v_mul_f32 v81, v81, v11
    v_mul_f32 v82, v82, v11
    v_mul_f32 v83, v83, v11
    v_mul_f32 v84, v84, v11
    v_mul_f32 v85, v85, v11
    v_mul_f32 v86, v86, v11
    v_mul_f32 v87, v87, v11
    v_mul_f32 v88, v88, v11
    v_mul_f32 v89, v89, v11
    v_mul_f32 v90, v90, v11
    v_mul_f32 v91, v91, v11
    v_mul_f32 v92, v92, v11
    v_mul_f32 v93, v93, v11
    v_mul_f32 v94, v94, v11
    v_mul_f32 v95, v95, v11
    v_mul_f32 v96, v96, v11
    v_mul_f32 v97, v97, v11
    v_mul_f32 v98, v98, v11
    v_mul_f32 v99, v99, v11
    v_mul_f32 v100, v100, v11
    v_mul_f32 v101, v101, v11
    v_mul_f32 v102, v102, v11
    v_mul_f32 v103, v103, v11
    v_mul_f32 v104, v104, v11
    v_mul_f32 v105, v105, v11
    v_mul_f32 v106, v106, v11
    v_mul_f32 v107, v107, v11
    v_mul_f32 v108, v108, v11
    v_mul_f32 v109, v109, v11
    v_mul_f32 v110, v110, v11
    v_mul_f32 v111, v111, v11
    v_cvt_pk_bf16_f32 v16, v48, v49
    v_cvt_pk_bf16_f32 v17, v50, v51
    v_cvt_pk_bf16_f32 v18, v52, v53
    v_cvt_pk_bf16_f32 v19, v54, v55
    v_cvt_pk_bf16_f32 v20, v56, v57
    v_cvt_pk_bf16_f32 v21, v58, v59
    v_cvt_pk_bf16_f32 v22, v60, v61
    v_cvt_pk_bf16_f32 v23, v62, v63
    v_cvt_pk_bf16_f32 v24, v64, v65
    v_cvt_pk_bf16_f32 v25, v66, v67
    v_cvt_pk_bf16_f32 v26, v68, v69
    v_cvt_pk_bf16_f32 v27, v70, v71
    v_cvt_pk_bf16_f32 v28, v72, v73
    v_cvt_pk_bf16_f32 v29, v74, v75
    v_cvt_pk_bf16_f32 v30, v76, v77
    v_cvt_pk_bf16_f32 v31, v78, v79
    v_cvt_pk_bf16_f32 v32, v80, v81
    v_cvt_pk_bf16_f32 v33, v82, v83
    v_cvt_pk_bf16_f32 v34, v84, v85
    v_cvt_pk_bf16_f32 v35, v86, v87
    v_cvt_pk_bf16_f32 v36, v88, v89
    v_cvt_pk_bf16_f32 v37, v90, v91
    v_cvt_pk_bf16_f32 v38, v92, v93
    v_cvt_pk_bf16_f32 v39, v94, v95
    v_cvt_pk_bf16_f32 v40, v96, v97
    v_cvt_pk_bf16_f32 v41, v98, v99
    v_cvt_pk_bf16_f32 v42, v100, v101
    v_cvt_pk_bf16_f32 v43, v102, v103
    v_cvt_pk_bf16_f32 v44, v104, v105
    v_cvt_pk_bf16_f32 v45, v106, v107
    v_cvt_pk_bf16_f32 v46, v108, v109
    v_cvt_pk_bf16_f32 v47, v110, v111
    v_mul_u32_u24 v9, 1040, v6
    v_lshl_add_u32 v9, v7, 4, v9
    ds_write_b128 v9, v[16:19] offset:0
    ds_write_b128 v9, v[20:23] offset:128
    ds_write_b128 v9, v[24:27] offset:256
    ds_write_b128 v9, v[28:31] offset:384
    ds_write_b128 v9, v[32:35] offset:512
    ds_write_b128 v9, v[36:39] offset:640
    ds_write_b128 v9, v[40:43] offset:768
    ds_write_b128 v9, v[44:47] offset:896
    s_waitcnt lgkmcnt(0)
    s_barrier
    v_mul_u32_u24 v9, 1040, v3
    v_lshl_add_u32 v9, v4, 4, v9
    s_lshl_b32 s27, s25, 5
    v_add_u32 v9, s27, v9
    v_mov_b32 v48, 0
    v_mov_b32 v49, 0
    v_mov_b32 v50, 0
    v_mov_b32 v51, 0
    v_mov_b32 v52, 0
    v_mov_b32 v53, 0
    v_mov_b32 v54, 0
    v_mov_b32 v55, 0
    v_mov_b32 v56, 0
    v_mov_b32 v57, 0
    v_mov_b32 v58, 0
    v_mov_b32 v59, 0
    v_mov_b32 v60, 0
    v_mov_b32 v61, 0
    v_mov_b32 v62, 0
    v_mov_b32 v63, 0
    v_mov_b32 v64, 0
    v_mov_b32 v65, 0
    v_mov_b32 v66, 0
    v_mov_b32 v67, 0
    v_mov_b32 v68, 0
    v_mov_b32 v69, 0
    v_mov_b32 v70, 0
    v_mov_b32 v71, 0
    v_mov_b32 v72, 0
    v_mov_b32 v73, 0
    v_mov_b32 v74, 0
    v_mov_b32 v75, 0
    v_mov_b32 v76, 0
    v_mov_b32 v77, 0
    v_mov_b32 v78, 0
    v_mov_b32 v79, 0
    v_mov_b32 v80, 0
    v_mov_b32 v81, 0
    v_mov_b32 v82, 0
    v_mov_b32 v83, 0
    v_mov_b32 v84, 0
    v_mov_b32 v85, 0
    v_mov_b32 v86, 0
    v_mov_b32 v87, 0
    v_mov_b32 v88, 0
    v_mov_b32 v89, 0
    v_mov_b32 v90, 0
    v_mov_b32 v91, 0
    v_mov_b32 v92, 0
    v_mov_b32 v93, 0
    v_mov_b32 v94, 0
    v_mov_b32 v95, 0
    v_mov_b32 v96, 0
    v_mov_b32 v97, 0
    v_mov_b32 v98, 0
    v_mov_b32 v99, 0
    v_mov_b32 v100, 0
    v_mov_b32 v101, 0
    v_mov_b32 v102, 0
    v_mov_b32 v103, 0
    v_mov_b32 v104, 0
    v_mov_b32 v105, 0
    v_mov_b32 v106, 0
    v_mov_b32 v107, 0
    v_mov_b32 v108, 0
    v_mov_b32 v109, 0
    v_mov_b32 v110, 0
    v_mov_b32 v111, 0
    ds_read_b128 v[40:43], v9 offset:0
    s_waitcnt vmcnt(32)
    v_perm_b32 v16, v130, v128, s40
    v_perm_b32 v17, v134, v132, s40
    v_perm_b32 v18, v138, v136, s40
    v_perm_b32 v19, v142, v140, s40
    v_perm_b32 v20, v130, v128, s41
    v_perm_b32 v21, v134, v132, s41
    v_perm_b32 v22, v138, v136, s41
    v_perm_b32 v23, v142, v140, s41
    v_perm_b32 v24, v131, v129, s40
    v_perm_b32 v25, v135, v133, s40
    v_perm_b32 v26, v139, v137, s40
    v_perm_b32 v27, v143, v141, s40
    v_perm_b32 v28, v131, v129, s41
    v_perm_b32 v29, v135, v133, s41
    v_perm_b32 v30, v139, v137, s41
    v_perm_b32 v31, v143, v141, s41
    s_waitcnt lgkmcnt(0)
    v_mfma_f32_32x32x16_bf16 v[48:63], v[16:19], v[40:43], v[48:63]
    v_mfma_f32_32x32x16_bf16 v[64:79], v[20:23], v[40:43], v[64:79]
    v_mfma_f32_32x32x16_bf16 v[80:95], v[24:27], v[40:43], v[80:95]
    v_mfma_f32_32x32x16_bf16 v[96:111], v[28:31], v[40:43], v[96:111]
    ds_read_b128 v[44:47], v9 offset:32
    v_perm_b32 v16, v146, v144, s40
    v_perm_b32 v17, v150, v148, s40
    v_perm_b32 v18, v154, v152, s40
    v_perm_b32 v19, v158, v156, s40
    v_perm_b32 v20, v146, v144, s41
    v_perm_b32 v21, v150, v148, s41
    v_perm_b32 v22, v154, v152, s41
    v_perm_b32 v23, v158, v156, s41
    v_perm_b32 v24, v147, v145, s40
    v_perm_b32 v25, v151, v149, s40
    v_perm_b32 v26, v155, v153, s40
    v_perm_b32 v27, v159, v157, s40
    v_perm_b32 v28, v147, v145, s41
    v_perm_b32 v29, v151, v149, s41
    v_perm_b32 v30, v155, v153, s41
    v_perm_b32 v31, v159, v157, s41
    s_waitcnt lgkmcnt(0)
    v_mfma_f32_32x32x16_bf16 v[48:63], v[16:19], v[44:47], v[48:63]
    v_mfma_f32_32x32x16_bf16 v[64:79], v[20:23], v[44:47], v[64:79]
    v_mfma_f32_32x32x16_bf16 v[80:95], v[24:27], v[44:47], v[80:95]
    v_mfma_f32_32x32x16_bf16 v[96:111], v[28:31], v[44:47], v[96:111]
    ds_read_b128 v[40:43], v9 offset:64
    v_perm_b32 v16, v162, v160, s40
    v_perm_b32 v17, v166, v164, s40
    v_perm_b32 v18, v170, v168, s40
    v_perm_b32 v19, v174, v172, s40
    v_perm_b32 v20, v162, v160, s41
    v_perm_b32 v21, v166, v164, s41
    v_perm_b32 v22, v170, v168, s41
    v_perm_b32 v23, v174, v172, s41
    v_perm_b32 v24, v163, v161, s40
    v_perm_b32 v25, v167, v165, s40
    v_perm_b32 v26, v171, v169, s40
    v_perm_b32 v27, v175, v173, s40
    v_perm_b32 v28, v163, v161, s41
    v_perm_b32 v29, v167, v165, s41
    v_perm_b32 v30, v171, v169, s41
    v_perm_b32 v31, v175, v173, s41
    s_waitcnt lgkmcnt(0)
    v_mfma_f32_32x32x16_bf16 v[48:63], v[16:19], v[40:43], v[48:63]
    v_mfma_f32_32x32x16_bf16 v[64:79], v[20:23], v[40:43], v[64:79]
    v_mfma_f32_32x32x16_bf16 v[80:95], v[24:27], v[40:43], v[80:95]
    v_mfma_f32_32x32x16_bf16 v[96:111], v[28:31], v[40:43], v[96:111]
    ds_read_b128 v[44:47], v9 offset:96
    v_perm_b32 v16, v178, v176, s40
    v_perm_b32 v17, v182, v180, s40
    v_perm_b32 v18, v186, v184, s40
    v_perm_b32 v19, v190, v188, s40
    v_perm_b32 v20, v178, v176, s41
    v_perm_b32 v21, v182, v180, s41
    v_perm_b32 v22, v186, v184, s41
    v_perm_b32 v23, v190, v188, s41
    v_perm_b32 v24, v179, v177, s40
    v_perm_b32 v25, v183, v181, s40
    v_perm_b32 v26, v187, v185, s40
    v_perm_b32 v27, v191, v189, s40
    v_perm_b32 v28, v179, v177, s41
    v_perm_b32 v29, v183, v181, s41
    v_perm_b32 v30, v187, v185, s41
    v_perm_b32 v31, v191, v189, s41
    s_waitcnt lgkmcnt(0)
    v_mfma_f32_32x32x16_bf16 v[48:63], v[16:19], v[44:47], v[48:63]
    v_mfma_f32_32x32x16_bf16 v[64:79], v[20:23], v[44:47], v[64:79]
    v_mfma_f32_32x32x16_bf16 v[80:95], v[24:27], v[44:47], v[80:95]
    v_mfma_f32_32x32x16_bf16 v[96:111], v[28:31], v[44:47], v[96:111]
    ds_read_b128 v[40:43], v9 offset:128
    s_waitcnt vmcnt(0)
    v_perm_b32 v16, v194, v192, s40
    v_perm_b32 v17, v198, v196, s40
    v_perm_b32 v18, v202, v200, s40
    v_perm_b32 v19, v206, v204, s40
    v_perm_b32 v20, v194, v192, s41
    v_perm_b32 v21, v198, v196, s41
    v_perm_b32 v22, v202, v200, s41
    v_perm_b32 v23, v206, v204, s41
    v_perm_b32 v24, v195, v193, s40
    v_perm_b32 v25, v199, v197, s40
    v_perm_b32 v26, v203, v201, s40
    v_perm_b32 v27, v207, v205, s40
    v_perm_b32 v28, v195, v193, s41
    v_perm_b32 v29, v199, v197, s41
    v_perm_b32 v30, v203, v201, s41
    v_perm_b32 v31, v207, v205, s41
    s_waitcnt lgkmcnt(0)
    v_mfma_f32_32x32x16_bf16 v[48:63], v[16:19], v[40:43], v[48:63]
    v_mfma_f32_32x32x16_bf16 v[64:79], v[20:23], v[40:43], v[64:79]
    v_mfma_f32_32x32x16_bf16 v[80:95], v[24:27], v[40:43], v[80:95]
    v_mfma_f32_32x32x16_bf16 v[96:111], v[28:31], v[40:43], v[96:111]
    ds_read_b128 v[44:47], v9 offset:160
    v_perm_b32 v16, v210, v208, s40
    v_perm_b32 v17, v214, v212, s40
    v_perm_b32 v18, v218, v216, s40
    v_perm_b32 v19, v222, v220, s40
    v_perm_b32 v20, v210, v208, s41
    v_perm_b32 v21, v214, v212, s41
    v_perm_b32 v22, v218, v216, s41
    v_perm_b32 v23, v222, v220, s41
    v_perm_b32 v24, v211, v209, s40
    v_perm_b32 v25, v215, v213, s40
    v_perm_b32 v26, v219, v217, s40
    v_perm_b32 v27, v223, v221, s40
    v_perm_b32 v28, v211, v209, s41
    v_perm_b32 v29, v215, v213, s41
    v_perm_b32 v30, v219, v217, s41
    v_perm_b32 v31, v223, v221, s41
    s_waitcnt lgkmcnt(0)
    v_mfma_f32_32x32x16_bf16 v[48:63], v[16:19], v[44:47], v[48:63]
    v_mfma_f32_32x32x16_bf16 v[64:79], v[20:23], v[44:47], v[64:79]
    v_mfma_f32_32x32x16_bf16 v[80:95], v[24:27], v[44:47], v[80:95]
    v_mfma_f32_32x32x16_bf16 v[96:111], v[28:31], v[44:47], v[96:111]
    ds_read_b128 v[40:43], v9 offset:192
    v_perm_b32 v16, v226, v224, s40
    v_perm_b32 v17, v230, v228, s40
    v_perm_b32 v18, v234, v232, s40
    v_perm_b32 v19, v238, v236, s40
    v_perm_b32 v20, v226, v224, s41
    v_perm_b32 v21, v230, v228, s41
    v_perm_b32 v22, v234, v232, s41
    v_perm_b32 v23, v238, v236, s41
    v_perm_b32 v24, v227, v225, s40
    v_perm_b32 v25, v231, v229, s40
    v_perm_b32 v26, v235, v233, s40
    v_perm_b32 v27, v239, v237, s40
    v_perm_b32 v28, v227, v225, s41
    v_perm_b32 v29, v231, v229, s41
    v_perm_b32 v30, v235, v233, s41
    v_perm_b32 v31, v239, v237, s41
    s_waitcnt lgkmcnt(0)
    v_mfma_f32_32x32x16_bf16 v[48:63], v[16:19], v[40:43], v[48:63]
    v_mfma_f32_32x32x16_bf16 v[64:79], v[20:23], v[40:43], v[64:79]
    v_mfma_f32_32x32x16_bf16 v[80:95], v[24:27], v[40:43], v[80:95]
    v_mfma_f32_32x32x16_bf16 v[96:111], v[28:31], v[40:43], v[96:111]
    ds_read_b128 v[44:47], v9 offset:224
    v_perm_b32 v16, v242, v240, s40
    v_perm_b32 v17, v246, v244, s40
    v_perm_b32 v18, v250, v248, s40
    v_perm_b32 v19, v254, v252, s40
    v_perm_b32 v20, v242, v240, s41
    v_perm_b32 v21, v246, v244, s41
    v_perm_b32 v22, v250, v248, s41
    v_perm_b32 v23, v254, v252, s41
    v_perm_b32 v24, v243, v241, s40
    v_perm_b32 v25, v247, v245, s40
    v_perm_b32 v26, v251, v249, s40
    v_perm_b32 v27, v255, v253, s40
    v_perm_b32 v28, v243, v241, s41
    v_perm_b32 v29, v247, v245, s41
    v_perm_b32 v30, v251, v249, s41
    v_perm_b32 v31, v255, v253, s41
    s_waitcnt lgkmcnt(0)
    v_mfma_f32_32x32x16_bf16 v[48:63], v[16:19], v[44:47], v[48:63]
    v_mfma_f32_32x32x16_bf16 v[64:79], v[20:23], v[44:47], v[64:79]
    v_mfma_f32_32x32x16_bf16 v[80:95], v[24:27], v[44:47], v[80:95]
    v_mfma_f32_32x32x16_bf16 v[96:111], v[28:31], v[44:47], v[96:111]
    s_nop 7
    s_nop 7
    s_waitcnt vmcnt(0)
    s_barrier
    v_lshlrev_b32 v9, 4, v2
    s_lshl_b32 s27, s5, 12
    v_add_u32 v10, s27, v9
    ds_write_b128 v10, v[48:51] offset:0
    ds_write_b128 v10, v[64:67] offset:1024
    ds_write_b128 v10, v[80:83] offset:2048
    ds_write_b128 v10, v[96:99] offset:3072
    ds_write_b128 v10, v[52:55] offset:16384
    ds_write_b128 v10, v[68:71] offset:17408
    ds_write_b128 v10, v[84:87] offset:18432
    ds_write_b128 v10, v[100:103] offset:19456
    ds_write_b128 v10, v[56:59] offset:32768
    ds_write_b128 v10, v[72:75] offset:33792
    ds_write_b128 v10, v[88:91] offset:34816
    ds_write_b128 v10, v[104:107] offset:35840
    ds_write_b128 v10, v[60:63] offset:49152
    ds_write_b128 v10, v[76:79] offset:50176
    ds_write_b128 v10, v[92:95] offset:51200
    ds_write_b128 v10, v[108:111] offset:52224
    s_waitcnt lgkmcnt(0)
    s_barrier
    s_lshl_b32 s27, s5, 14
    v_add_u32 v10, s27, v9
    ds_read_b128 v[128:131], v10 offset:0
    ds_read_b128 v[132:135], v10 offset:1024
    ds_read_b128 v[136:139], v10 offset:2048
    ds_read_b128 v[140:143], v10 offset:3072
    ds_read_b128 v[144:147], v10 offset:4096
    ds_read_b128 v[148:151], v10 offset:5120
    ds_read_b128 v[152:155], v10 offset:6144
    ds_read_b128 v[156:159], v10 offset:7168
    ds_read_b128 v[160:163], v10 offset:8192
    ds_read_b128 v[164:167], v10 offset:9216
    ds_read_b128 v[168:171], v10 offset:10240
    ds_read_b128 v[172:175], v10 offset:11264
    ds_read_b128 v[176:179], v10 offset:12288
    ds_read_b128 v[180:183], v10 offset:13312
    ds_read_b128 v[184:187], v10 offset:14336
    ds_read_b128 v[188:191], v10 offset:15360
    s_waitcnt lgkmcnt(0)
    v_add_f32 v48, v128, v144
    v_add_f32 v64, v160, v176
    v_add_f32 v49, v129, v145
    v_add_f32 v65, v161, v177
    v_add_f32 v50, v130, v146
    v_add_f32 v66, v162, v178
    v_add_f32 v51, v131, v147
    v_add_f32 v67, v163, v179
    v_add_f32 v52, v132, v148
    v_add_f32 v68, v164, v180
    v_add_f32 v53, v133, v149
    v_add_f32 v69, v165, v181
    v_add_f32 v54, v134, v150
    v_add_f32 v70, v166, v182
    v_add_f32 v55, v135, v151
    v_add_f32 v71, v167, v183
    v_add_f32 v56, v136, v152
    v_add_f32 v72, v168, v184
    v_add_f32 v57, v137, v153
    v_add_f32 v73, v169, v185
    v_add_f32 v58, v138, v154
    v_add_f32 v74, v170, v186
    v_add_f32 v59, v139, v155
    v_add_f32 v75, v171, v187
    v_add_f32 v60, v140, v156
    v_add_f32 v76, v172, v188
    v_add_f32 v61, v141, v157
    v_add_f32 v77, v173, v189
    v_add_f32 v62, v142, v158
    v_add_f32 v78, v174, v190
    v_add_f32 v63, v143, v159
    v_add_f32 v79, v175, v191
    v_add_f32 v48, v48, v64
    v_add_f32 v49, v49, v65
    v_add_f32 v50, v50, v66
    v_add_f32 v51, v51, v67
    v_add_f32 v52, v52, v68
    v_add_f32 v53, v53, v69
    v_add_f32 v54, v54, v70
    v_add_f32 v55, v55, v71
    v_add_f32 v56, v56, v72
    v_add_f32 v57, v57, v73
    v_add_f32 v58, v58, v74
    v_add_f32 v59, v59, v75
    v_add_f32 v60, v60, v76
    v_add_f32 v61, v61, v77
    v_add_f32 v62, v62, v78
    v_add_f32 v63, v63, v79
    v_add_u32 v8, s24, v3
    s_lshl_b32 s27, s4, 8
    s_lshl_b32 s28, s5, 6
    s_add_u32 s27, s27, s28
    v_lshlrev_b32 v9, 5, v4
    v_add_u32 v9, s27, v9
    s_mov_b32 s42, 0x3d372713
    s_mov_b32 s43, 0xc0135761
    v_mul_f32 v16, v48, v48
    v_fma_f32 v16, v16, s42, 1.0
    v_mul_f32 v16, v16, v48
    v_mul_f32 v16, s43, v16
    v_exp_f32 v16, v16
    s_nop 0
    v_add_f32 v16, 1.0, v16
    v_rcp_f32 v16, v16
    s_nop 0
    v_mul_f32 v48, v48, v16
    v_mul_f32 v16, v49, v49
    v_fma_f32 v16, v16, s42, 1.0
    v_mul_f32 v16, v16, v49
    v_mul_f32 v16, s43, v16
    v_exp_f32 v16, v16
    s_nop 0
    v_add_f32 v16, 1.0, v16
    v_rcp_f32 v16, v16
    s_nop 0
    v_mul_f32 v49, v49, v16
    v_mul_f32 v16, v50, v50
    v_fma_f32 v16, v16, s42, 1.0
    v_mul_f32 v16, v16, v50
    v_mul_f32 v16, s43, v16
    v_exp_f32 v16, v16
    s_nop 0
    v_add_f32 v16, 1.0, v16
    v_rcp_f32 v16, v16
    s_nop 0
    v_mul_f32 v50, v50, v16
    v_mul_f32 v16, v51, v51
    v_fma_f32 v16, v16, s42, 1.0
    v_mul_f32 v16, v16, v51
    v_mul_f32 v16, s43, v16
    v_exp_f32 v16, v16
    s_nop 0
    v_add_f32 v16, 1.0, v16
    v_rcp_f32 v16, v16
    s_nop 0
    v_mul_f32 v51, v51, v16
    v_mul_f32 v16, v52, v52
    v_fma_f32 v16, v16, s42, 1.0
    v_mul_f32 v16, v16, v52
    v_mul_f32 v16, s43, v16
    v_exp_f32 v16, v16
    s_nop 0
    v_add_f32 v16, 1.0, v16
    v_rcp_f32 v16, v16
    s_nop 0
    v_mul_f32 v52, v52, v16
    v_mul_f32 v16, v53, v53
    v_fma_f32 v16, v16, s42, 1.0
    v_mul_f32 v16, v16, v53
    v_mul_f32 v16, s43, v16
    v_exp_f32 v16, v16
    s_nop 0
    v_add_f32 v16, 1.0, v16
    v_rcp_f32 v16, v16
    s_nop 0
    v_mul_f32 v53, v53, v16
    v_mul_f32 v16, v54, v54
    v_fma_f32 v16, v16, s42, 1.0
    v_mul_f32 v16, v16, v54
    v_mul_f32 v16, s43, v16
    v_exp_f32 v16, v16
    s_nop 0
    v_add_f32 v16, 1.0, v16
    v_rcp_f32 v16, v16
    s_nop 0
    v_mul_f32 v54, v54, v16
    v_mul_f32 v16, v55, v55
    v_fma_f32 v16, v16, s42, 1.0
    v_mul_f32 v16, v16, v55
    v_mul_f32 v16, s43, v16
    v_exp_f32 v16, v16
    s_nop 0
    v_add_f32 v16, 1.0, v16
    v_rcp_f32 v16, v16
    s_nop 0
    v_mul_f32 v55, v55, v16
    v_mul_f32 v16, v56, v56
    v_fma_f32 v16, v16, s42, 1.0
    v_mul_f32 v16, v16, v56
    v_mul_f32 v16, s43, v16
    v_exp_f32 v16, v16
    s_nop 0
    v_add_f32 v16, 1.0, v16
    v_rcp_f32 v16, v16
    s_nop 0
    v_mul_f32 v56, v56, v16
    v_mul_f32 v16, v57, v57
    v_fma_f32 v16, v16, s42, 1.0
    v_mul_f32 v16, v16, v57
    v_mul_f32 v16, s43, v16
    v_exp_f32 v16, v16
    s_nop 0
    v_add_f32 v16, 1.0, v16
    v_rcp_f32 v16, v16
    s_nop 0
    v_mul_f32 v57, v57, v16
    v_mul_f32 v16, v58, v58
    v_fma_f32 v16, v16, s42, 1.0
    v_mul_f32 v16, v16, v58
    v_mul_f32 v16, s43, v16
    v_exp_f32 v16, v16
    s_nop 0
    v_add_f32 v16, 1.0, v16
    v_rcp_f32 v16, v16
    s_nop 0
    v_mul_f32 v58, v58, v16
    v_mul_f32 v16, v59, v59
    v_fma_f32 v16, v16, s42, 1.0
    v_mul_f32 v16, v16, v59
    v_mul_f32 v16, s43, v16
    v_exp_f32 v16, v16
    s_nop 0
    v_add_f32 v16, 1.0, v16
    v_rcp_f32 v16, v16
    s_nop 0
    v_mul_f32 v59, v59, v16
    v_mul_f32 v16, v60, v60
    v_fma_f32 v16, v16, s42, 1.0
    v_mul_f32 v16, v16, v60
    v_mul_f32 v16, s43, v16
    v_exp_f32 v16, v16
    s_nop 0
    v_add_f32 v16, 1.0, v16
    v_rcp_f32 v16, v16
    s_nop 0
    v_mul_f32 v60, v60, v16
    v_mul_f32 v16, v61, v61
    v_fma_f32 v16, v16, s42, 1.0
    v_mul_f32 v16, v16, v61
    v_mul_f32 v16, s43, v16
    v_exp_f32 v16, v16
    s_nop 0
    v_add_f32 v16, 1.0, v16
    v_rcp_f32 v16, v16
    s_nop 0
    v_mul_f32 v61, v61, v16
    v_mul_f32 v16, v62, v62
    v_fma_f32 v16, v16, s42, 1.0
    v_mul_f32 v16, v16, v62
    v_mul_f32 v16, s43, v16
    v_exp_f32 v16, v16
    s_nop 0
    v_add_f32 v16, 1.0, v16
    v_rcp_f32 v16, v16
    s_nop 0
    v_mul_f32 v62, v62, v16
    v_mul_f32 v16, v63, v63
    v_fma_f32 v16, v16, s42, 1.0
    v_mul_f32 v16, v16, v63
    v_mul_f32 v16, s43, v16
    v_exp_f32 v16, v16
    s_nop 0
    v_add_f32 v16, 1.0, v16
    v_rcp_f32 v16, v16
    s_nop 0
    v_mul_f32 v63, v63, v16
    v_mul_u32_u24 v10, 1024, v8
    v_add_u32 v10, v10, v9
    s_add_u32 s28, s6, 0xc00000
    s_addc_u32 s29, s7, 0
    s_mov_b32 s30, 0x200000
    s_mov_b32 s31, 0x00020000
    v_cvt_pk_bf16_f32 v16, v48, v52
    v_cvt_pk_bf16_f32 v17, v56, v60
    v_cvt_pk_bf16_f32 v18, v49, v53
    v_cvt_pk_bf16_f32 v19, v57, v61
    v_cvt_pk_bf16_f32 v20, v50, v54
    v_cvt_pk_bf16_f32 v21, v58, v62
    v_cvt_pk_bf16_f32 v22, v51, v55
    v_cvt_pk_bf16_f32 v23, v59, v63
    buffer_store_dwordx4 v[16:19], v10, s[28:31], 0 offen
    buffer_store_dwordx4 v[20:23], v10, s[28:31], 0 offen offset:16
L_end_k4_kernel:
    s_endpgm
.section .rodata,"a"
.p2align 6
.amdhsa_kernel k4_kernel
  .amdhsa_next_free_vgpr 256
  .amdhsa_next_free_sgpr 96
  .amdhsa_accum_offset 256
  .amdhsa_group_segment_fixed_size 0
  .amdhsa_kernarg_size 88
  .amdhsa_user_sgpr_count 2
  .amdhsa_user_sgpr_kernarg_segment_ptr 1
  .amdhsa_system_sgpr_workgroup_id_x 1
.end_amdhsa_kernel
.text

.globl k5_kernel
.p2align 8
.type k5_kernel,@function
k5_kernel:
    s_and_b32 s3, s2, 63
    s_lshr_b32 s4, s2, 6
    s_cmp_ge_u32 s4, 4
    s_cbranch_scc1 L_end_k5_kernel
    s_load_dwordx2 s[6:7], s[0:1], 80
    s_load_dwordx2 s[8:9], s[0:1], 40
    s_load_dwordx2 s[10:11], s[0:1], 0
    s_load_dwordx2 s[12:13], s[0:1], 64
    v_lshrrev_b32 v1, 6, v0
    v_and_b32 v2, 63, v0
    v_and_b32 v3, 31, v2
    v_lshrrev_b32 v4, 5, v2
    v_readfirstlane_b32 s5, v1
    s_mov_b32 s40, 0x05040100
    s_mov_b32 s41, 0x07060302
    s_waitcnt lgkmcnt(0)
    s_add_u32 s16, s6, 0xc00000
    s_addc_u32 s17, s7, 0
    s_mov_b32 s18, 0x200000
    s_mov_b32 s19, 0x00020000
    s_mov_b32 s20, s8
    s_mov_b32 s21, s9
    s_mov_b32 s22, 0x80000
    s_mov_b32 s23, 0x00020000
    s_lshl_b32 s24, s3, 5
    s_mul_i32 s25, s5, 8
    s_lshl_b32 s26, s4, 8
    s_mul_i32 s27, s25, 16384
    s_add_u32 s26, s26, s27
    v_mul_u32_u24 v5, 8192, v4
    v_lshl_add_u32 v5, v3, 3, v5
    v_add_u32 v8, s24, v3
    v_mul_u32_u24 v8, 1024, v8
    v_lshl_add_u32 v8, v4, 4, v8
    s_lshl_b32 s27, s25, 5
    v_add_u32 v12, s27, v8
    s_mov_b32 s27, 0xfffffc00
    s_cmp_eq_u32 s5, 1
    s_cselect_b32 s27, 1024, s27
    s_cmp_eq_u32 s5, 2
    s_cselect_b32 s27, 0xfffff800, s27
    s_cmp_eq_u32 s5, 3
    s_cselect_b32 s27, 2048, s27
    v_add_u32 v12, s27, v12
    buffer_load_dwordx4 v[112:115], v12, s[16:19], 0 offen offset:0
    buffer_load_dwordx4 v[116:119], v12, s[16:19], 0 offen offset:32
    buffer_load_dwordx4 v[120:123], v12, s[16:19], 0 offen offset:64
    buffer_load_dwordx4 v[124:127], v12, s[16:19], 0 offen offset:96
    buffer_load_dwordx2 v[128:129], v5, s[20:23], s26 offen offset:0
    buffer_load_dwordx2 v[130:131], v5, s[20:23], s26 offen offset:1024
    buffer_load_dwordx2 v[132:133], v5, s[20:23], s26 offen offset:2048
    buffer_load_dwordx2 v[134:135], v5, s[20:23], s26 offen offset:3072
    s_add_u32 s28, s26, 0x1000
    buffer_load_dwordx2 v[136:137], v5, s[20:23], s28 offen
    s_add_u32 s28, s26, 0x1400
    buffer_load_dwordx2 v[138:139], v5, s[20:23], s28 offen
    s_add_u32 s28, s26, 0x1800
    buffer_load_dwordx2 v[140:141], v5, s[20:23], s28 offen
    s_add_u32 s28, s26, 0x1c00
    buffer_load_dwordx2 v[142:143], v5, s[20:23], s28 offen
    s_add_u32 s28, s26, 0x4000
    buffer_load_dwordx2 v[144:145], v5, s[20:23], s28 offen
    s_add_u32 s28, s26, 0x4400
    buffer_load_dwordx2 v[146:147], v5, s[20:23], s28 offen
    s_add_u32 s28, s26, 0x4800
    buffer_load_dwordx2 v[148:149], v5, s[20:23], s28 offen
    s_add_u32 s28, s26, 0x4c00
    buffer_load_dwordx2 v[150:151], v5, s[20:23], s28 offen
    s_add_u32 s28, s26, 0x5000
    buffer_load_dwordx2 v[152:153], v5, s[20:23], s28 offen
    s_add_u32 s28, s26, 0x5400
    buffer_load_dwordx2 v[154:155], v5, s[20:23], s28 offen
    s_add_u32 s28, s26, 0x5800
    buffer_load_dwordx2 v[156:157], v5, s[20:23], s28 offen
    s_add_u32 s28, s26, 0x5c00
    buffer_load_dwordx2 v[158:159], v5, s[20:23], s28 offen
    s_add_u32 s28, s26, 0x8000
    buffer_load_dwordx2 v[160:161], v5, s[20:23], s28 offen
    s_add_u32 s28, s26, 0x8400
    buffer_load_dwordx2 v[162:163], v5, s[20:23], s28 offen
    s_add_u32 s28, s26, 0x8800
    buffer_load_dwordx2 v[164:165], v5, s[20:23], s28 offen
    s_add_u32 s28, s26, 0x8c00
    buffer_load_dwordx2 v[166:167], v5, s[20:23], s28 offen
    s_add_u32 s28, s26, 0x9000
    buffer_load_dwordx2 v[168:169], v5, s[20:23], s28 offen
    s_add_u32 s28, s26, 0x9400
    buffer_load_dwordx2 v[170:171], v5, s[20:23], s28 offen
    s_add_u32 s28, s26, 0x9800
    buffer_load_dwordx2 v[172:173], v5, s[20:23], s28 offen
    s_add_u32 s28, s26, 0x9c00
    buffer_load_dwordx2 v[174:175], v5, s[20:23], s28 offen
    s_add_u32 s28, s26, 0xc000
    buffer_load_dwordx2 v[176:177], v5, s[20:23], s28 offen
    s_add_u32 s28, s26, 0xc400
    buffer_load_dwordx2 v[178:179], v5, s[20:23], s28 offen
    s_add_u32 s28, s26, 0xc800
    buffer_load_dwordx2 v[180:181], v5, s[20:23], s28 offen
    s_add_u32 s28, s26, 0xcc00
    buffer_load_dwordx2 v[182:183], v5, s[20:23], s28 offen
    s_add_u32 s28, s26, 0xd000
    buffer_load_dwordx2 v[184:185], v5, s[20:23], s28 offen
    s_add_u32 s28, s26, 0xd400
    buffer_load_dwordx2 v[186:187], v5, s[20:23], s28 offen
    s_add_u32 s28, s26, 0xd800
    buffer_load_dwordx2 v[188:189], v5, s[20:23], s28 offen
    s_add_u32 s28, s26, 0xdc00
    buffer_load_dwordx2 v[190:191], v5, s[20:23], s28 offen
    buffer_load_dwordx4 v[32:35], v12, s[16:19], 0 offen offset:128
    buffer_load_dwordx4 v[36:39], v12, s[16:19], 0 offen offset:160
    buffer_load_dwordx4 v[40:43], v12, s[16:19], 0 offen offset:192
    buffer_load_dwordx4 v[44:47], v12, s[16:19], 0 offen offset:224
    s_add_u32 s28, s26, 0x10000
    buffer_load_dwordx2 v[192:193], v5, s[20:23], s28 offen
    s_add_u32 s28, s26, 0x10400
    buffer_load_dwordx2 v[194:195], v5, s[20:23], s28 offen
    s_add_u32 s28, s26, 0x10800
    buffer_load_dwordx2 v[196:197], v5, s[20:23], s28 offen
    s_add_u32 s28, s26, 0x10c00
    buffer_load_dwordx2 v[198:199], v5, s[20:23], s28 offen
    s_add_u32 s28, s26, 0x11000
    buffer_load_dwordx2 v[200:201], v5, s[20:23], s28 offen
    s_add_u32 s28, s26, 0x11400
    buffer_load_dwordx2 v[202:203], v5, s[20:23], s28 offen
    s_add_u32 s28, s26, 0x11800
    buffer_load_dwordx2 v[204:205], v5, s[20:23], s28 offen
    s_add_u32 s28, s26, 0x11c00
    buffer_load_dwordx2 v[206:207], v5, s[20:23], s28 offen
    s_add_u32 s28, s26, 0x14000
    buffer_load_dwordx2 v[208:209], v5, s[20:23], s28 offen
    s_add_u32 s28, s26, 0x14400
    buffer_load_dwordx2 v[210:211], v5, s[20:23], s28 offen
    s_add_u32 s28, s26, 0x14800
    buffer_load_dwordx2 v[212:213], v5, s[20:23], s28 offen
    s_add_u32 s28, s26, 0x14c00
    buffer_load_dwordx2 v[214:215], v5, s[20:23], s28 offen
    s_add_u32 s28, s26, 0x15000
    buffer_load_dwordx2 v[216:217], v5, s[20:23], s28 offen
    s_add_u32 s28, s26, 0x15400
    buffer_load_dwordx2 v[218:219], v5, s[20:23], s28 offen
    s_add_u32 s28, s26, 0x15800
    buffer_load_dwordx2 v[220:221], v5, s[20:23], s28 offen
    s_add_u32 s28, s26, 0x15c00
    buffer_load_dwordx2 v[222:223], v5, s[20:23], s28 offen
    s_add_u32 s28, s26, 0x18000
    buffer_load_dwordx2 v[224:225], v5, s[20:23], s28 offen
    s_add_u32 s28, s26, 0x18400
    buffer_load_dwordx2 v[226:227], v5, s[20:23], s28 offen
    s_add_u32 s28, s26, 0x18800
    buffer_load_dwordx2 v[228:229], v5, s[20:23], s28 offen
    s_add_u32 s28, s26, 0x18c00
    buffer_load_dwordx2 v[230:231], v5, s[20:23], s28 offen
    s_add_u32 s28, s26, 0x19000
    buffer_load_dwordx2 v[232:233], v5, s[20:23], s28 offen
    s_add_u32 s28, s26, 0x19400
    buffer_load_dwordx2 v[234:235], v5, s[20:23], s28 offen
    s_add_u32 s28, s26, 0x19800
    buffer_load_dwordx2 v[236:237], v5, s[20:23], s28 offen
    s_add_u32 s28, s26, 0x19c00
    buffer_load_dwordx2 v[238:239], v5, s[20:23], s28 offen
    s_add_u32 s28, s26, 0x1c000
    buffer_load_dwordx2 v[240:241], v5, s[20:23], s28 offen
    s_add_u32 s28, s26, 0x1c400
    buffer_load_dwordx2 v[242:243], v5, s[20:23], s28 offen
    s_add_u32 s28, s26, 0x1c800
    buffer_load_dwordx2 v[244:245], v5, s[20:23], s28 offen
    s_add_u32 s28, s26, 0x1cc00
    buffer_load_dwordx2 v[246:247], v5, s[20:23], s28 offen
    s_add_u32 s28, s26, 0x1d000
    buffer_load_dwordx2 v[248:249], v5, s[20:23], s28 offen
    s_add_u32 s28, s26, 0x1d400
    buffer_load_dwordx2 v[250:251], v5, s[20:23], s28 offen
    s_add_u32 s28, s26, 0x1d800
    buffer_load_dwordx2 v[252:253], v5, s[20:23], s28 offen
    s_add_u32 s28, s26, 0x1dc00
    buffer_load_dwordx2 v[254:255], v5, s[20:23], s28 offen
    v_mov_b32 v48, 0
    v_mov_b32 v49, 0
    v_mov_b32 v50, 0
    v_mov_b32 v51, 0
    v_mov_b32 v52, 0
    v_mov_b32 v53, 0
    v_mov_b32 v54, 0
    v_mov_b32 v55, 0
    v_mov_b32 v56, 0
    v_mov_b32 v57, 0
    v_mov_b32 v58, 0
    v_mov_b32 v59, 0
    v_mov_b32 v60, 0
    v_mov_b32 v61, 0
    v_mov_b32 v62, 0
    v_mov_b32 v63, 0
    v_mov_b32 v64, 0
    v_mov_b32 v65, 0
    v_mov_b32 v66, 0
    v_mov_b32 v67, 0
    v_mov_b32 v68, 0
    v_mov_b32 v69, 0
    v_mov_b32 v70, 0
    v_mov_b32 v71, 0
    v_mov_b32 v72, 0
    v_mov_b32 v73, 0
    v_mov_b32 v74, 0
    v_mov_b32 v75, 0
    v_mov_b32 v76, 0
    v_mov_b32 v77, 0
    v_mov_b32 v78, 0
    v_mov_b32 v79, 0
    v_mov_b32 v80, 0
    v_mov_b32 v81, 0
    v_mov_b32 v82, 0
    v_mov_b32 v83, 0
    v_mov_b32 v84, 0
    v_mov_b32 v85, 0
    v_mov_b32 v86, 0
    v_mov_b32 v87, 0
    v_mov_b32 v88, 0
    v_mov_b32 v89, 0
    v_mov_b32 v90, 0
    v_mov_b32 v91, 0
    v_mov_b32 v92, 0
    v_mov_b32 v93, 0
    v_mov_b32 v94, 0
    v_mov_b32 v95, 0
    v_mov_b32 v96, 0
    v_mov_b32 v97, 0
    v_mov_b32 v98, 0
    v_mov_b32 v99, 0
    v_mov_b32 v100, 0
    v_mov_b32 v101, 0
    v_mov_b32 v102, 0
    v_mov_b32 v103, 0
    v_mov_b32 v104, 0
    v_mov_b32 v105, 0
    v_mov_b32 v106, 0
    v_mov_b32 v107, 0
    v_mov_b32 v108, 0
    v_mov_b32 v109, 0
    v_mov_b32 v110, 0
    v_mov_b32 v111, 0
    s_waitcnt vmcnt(36)
    v_perm_b32 v16, v130, v128, s40
    v_perm_b32 v17, v134, v132, s40
    v_perm_b32 v18, v138, v136, s40
    v_perm_b32 v19, v142, v140, s40
    v_perm_b32 v20, v130, v128, s41
    v_perm_b32 v21, v134, v132, s41
    v_perm_b32 v22, v138, v136, s41
    v_perm_b32 v23, v142, v140, s41
    v_perm_b32 v24, v131, v129, s40
    v_perm_b32 v25, v135, v133, s40
    v_perm_b32 v26, v139, v137, s40
    v_perm_b32 v27, v143, v141, s40
    v_perm_b32 v28, v131, v129, s41
    v_perm_b32 v29, v135, v133, s41
    v_perm_b32 v30, v139, v137, s41
    v_perm_b32 v31, v143, v141, s41
    s_nop 1
    v_mfma_f32_32x32x16_bf16 v[48:63], v[16:19], v[112:115], v[48:63]
    v_mfma_f32_32x32x16_bf16 v[64:79], v[20:23], v[112:115], v[64:79]
    v_mfma_f32_32x32x16_bf16 v[80:95], v[24:27], v[112:115], v[80:95]
    v_mfma_f32_32x32x16_bf16 v[96:111], v[28:31], v[112:115], v[96:111]
    v_perm_b32 v16, v146, v144, s40
    v_perm_b32 v17, v150, v148, s40
    v_perm_b32 v18, v154, v152, s40
    v_perm_b32 v19, v158, v156, s40
    v_perm_b32 v20, v146, v144, s41
    v_perm_b32 v21, v150, v148, s41
    v_perm_b32 v22, v154, v152, s41
    v_perm_b32 v23, v158, v156, s41
    v_perm_b32 v24, v147, v145, s40
    v_perm_b32 v25, v151, v149, s40
    v_perm_b32 v26, v155, v153, s40
    v_perm_b32 v27, v159, v157, s40
    v_perm_b32 v28, v147, v145, s41
    v_perm_b32 v29, v151, v149, s41
    v_perm_b32 v30, v155, v153, s41
    v_perm_b32 v31, v159, v157, s41
    s_nop 1
    v_mfma_f32_32x32x16_bf16 v[48:63], v[16:19], v[116:119], v[48:63]
    v_mfma_f32_32x32x16_bf16 v[64:79], v[20:23], v[116:119], v[64:79]
    v_mfma_f32_32x32x16_bf16 v[80:95], v[24:27], v[116:119], v[80:95]
    v_mfma_f32_32x32x16_bf16 v[96:111], v[28:31], v[116:119], v[96:111]
    v_perm_b32 v16, v162, v160, s40
    v_perm_b32 v17, v166, v164, s40
    v_perm_b32 v18, v170, v168, s40
    v_perm_b32 v19, v174, v172, s40
    v_perm_b32 v20, v162, v160, s41
    v_perm_b32 v21, v166, v164, s41
    v_perm_b32 v22, v170, v168, s41
    v_perm_b32 v23, v174, v172, s41
    v_perm_b32 v24, v163, v161, s40
    v_perm_b32 v25, v167, v165, s40
    v_perm_b32 v26, v171, v169, s40
    v_perm_b32 v27, v175, v173, s40
    v_perm_b32 v28, v163, v161, s41
    v_perm_b32 v29, v167, v165, s41
    v_perm_b32 v30, v171, v169, s41
    v_perm_b32 v31, v175, v173, s41
    s_nop 1
    v_mfma_f32_32x32x16_bf16 v[48:63], v[16:19], v[120:123], v[48:63]
    v_mfma_f32_32x32x16_bf16 v[64:79], v[20:23], v[120:123], v[64:79]
    v_mfma_f32_32x32x16_bf16 v[80:95], v[24:27], v[120:123], v[80:95]
    v_mfma_f32_32x32x16_bf16 v[96:111], v[28:31], v[120:123], v[96:111]
    v_perm_b32 v16, v178, v176, s40
    v_perm_b32 v17, v182, v180, s40
    v_perm_b32 v18, v186, v184, s40
    v_perm_b32 v19, v190, v188, s40
    v_perm_b32 v20, v178, v176, s41
    v_perm_b32 v21, v182, v180, s41
    v_perm_b32 v22, v186, v184, s41
    v_perm_b32 v23, v190, v188, s41
    v_perm_b32 v24, v179, v177, s40
    v_perm_b32 v25, v183, v181, s40
    v_perm_b32 v26, v187, v185, s40
    v_perm_b32 v27, v191, v189, s40
    v_perm_b32 v28, v179, v177, s41
    v_perm_b32 v29, v183, v181, s41
    v_perm_b32 v30, v187, v185, s41
    v_perm_b32 v31, v191, v189, s41
    s_nop 1
    v_mfma_f32_32x32x16_bf16 v[48:63], v[16:19], v[124:127], v[48:63]
    v_mfma_f32_32x32x16_bf16 v[64:79], v[20:23], v[124:127], v[64:79]
    v_mfma_f32_32x32x16_bf16 v[80:95], v[24:27], v[124:127], v[80:95]
    v_mfma_f32_32x32x16_bf16 v[96:111], v[28:31], v[124:127], v[96:111]
    s_waitcnt vmcnt(0)
    v_perm_b32 v16, v194, v192, s40
    v_perm_b32 v17, v198, v196, s40
    v_perm_b32 v18, v202, v200, s40
    v_perm_b32 v19, v206, v204, s40
    v_perm_b32 v20, v194, v192, s41
    v_perm_b32 v21, v198, v196, s41
    v_perm_b32 v22, v202, v200, s41
    v_perm_b32 v23, v206, v204, s41
    v_perm_b32 v24, v195, v193, s40
    v_perm_b32 v25, v199, v197, s40
    v_perm_b32 v26, v203, v201, s40
    v_perm_b32 v27, v207, v205, s40
    v_perm_b32 v28, v195, v193, s41
    v_perm_b32 v29, v199, v197, s41
    v_perm_b32 v30, v203, v201, s41
    v_perm_b32 v31, v207, v205, s41
    s_nop 1
    v_mfma_f32_32x32x16_bf16 v[48:63], v[16:19], v[32:35], v[48:63]
    v_mfma_f32_32x32x16_bf16 v[64:79], v[20:23], v[32:35], v[64:79]
    v_mfma_f32_32x32x16_bf16 v[80:95], v[24:27], v[32:35], v[80:95]
    v_mfma_f32_32x32x16_bf16 v[96:111], v[28:31], v[32:35], v[96:111]
    v_perm_b32 v16, v210, v208, s40
    v_perm_b32 v17, v214, v212, s40
    v_perm_b32 v18, v218, v216, s40
    v_perm_b32 v19, v222, v220, s40
    v_perm_b32 v20, v210, v208, s41
    v_perm_b32 v21, v214, v212, s41
    v_perm_b32 v22, v218, v216, s41
    v_perm_b32 v23, v222, v220, s41
    v_perm_b32 v24, v211, v209, s40
    v_perm_b32 v25, v215, v213, s40
    v_perm_b32 v26, v219, v217, s40
    v_perm_b32 v27, v223, v221, s40
    v_perm_b32 v28, v211, v209, s41
    v_perm_b32 v29, v215, v213, s41
    v_perm_b32 v30, v219, v217, s41
    v_perm_b32 v31, v223, v221, s41
    s_nop 1
    v_mfma_f32_32x32x16_bf16 v[48:63], v[16:19], v[36:39], v[48:63]
    v_mfma_f32_32x32x16_bf16 v[64:79], v[20:23], v[36:39], v[64:79]
    v_mfma_f32_32x32x16_bf16 v[80:95], v[24:27], v[36:39], v[80:95]
    v_mfma_f32_32x32x16_bf16 v[96:111], v[28:31], v[36:39], v[96:111]
    v_perm_b32 v16, v226, v224, s40
    v_perm_b32 v17, v230, v228, s40
    v_perm_b32 v18, v234, v232, s40
    v_perm_b32 v19, v238, v236, s40
    v_perm_b32 v20, v226, v224, s41
    v_perm_b32 v21, v230, v228, s41
    v_perm_b32 v22, v234, v232, s41
    v_perm_b32 v23, v238, v236, s41
    v_perm_b32 v24, v227, v225, s40
    v_perm_b32 v25, v231, v229, s40
    v_perm_b32 v26, v235, v233, s40
    v_perm_b32 v27, v239, v237, s40
    v_perm_b32 v28, v227, v225, s41
    v_perm_b32 v29, v231, v229, s41
    v_perm_b32 v30, v235, v233, s41
    v_perm_b32 v31, v239, v237, s41
    s_nop 1
    v_mfma_f32_32x32x16_bf16 v[48:63], v[16:19], v[40:43], v[48:63]
    v_mfma_f32_32x32x16_bf16 v[64:79], v[20:23], v[40:43], v[64:79]
    v_mfma_f32_32x32x16_bf16 v[80:95], v[24:27], v[40:43], v[80:95]
    v_mfma_f32_32x32x16_bf16 v[96:111], v[28:31], v[40:43], v[96:111]
    v_perm_b32 v16, v242, v240, s40
    v_perm_b32 v17, v246, v244, s40
    v_perm_b32 v18, v250, v248, s40
    v_perm_b32 v19, v254, v252, s40
    v_perm_b32 v20, v242, v240, s41
    v_perm_b32 v21, v246, v244, s41
    v_perm_b32 v22, v250, v248, s41
    v_perm_b32 v23, v254, v252, s41
    v_perm_b32 v24, v243, v241, s40
    v_perm_b32 v25, v247, v245, s40
    v_perm_b32 v26, v251, v249, s40
    v_perm_b32 v27, v255, v253, s40
    v_perm_b32 v28, v243, v241, s41
    v_perm_b32 v29, v247, v245, s41
    v_perm_b32 v30, v251, v249, s41
    v_perm_b32 v31, v255, v253, s41
    s_nop 1
    v_mfma_f32_32x32x16_bf16 v[48:63], v[16:19], v[44:47], v[48:63]
    v_mfma_f32_32x32x16_bf16 v[64:79], v[20:23], v[44:47], v[64:79]
    v_mfma_f32_32x32x16_bf16 v[80:95], v[24:27], v[44:47], v[80:95]
    v_mfma_f32_32x32x16_bf16 v[96:111], v[28:31], v[44:47], v[96:111]
    s_nop 7
    s_nop 7
    s_waitcnt vmcnt(0)
    s_barrier
    v_lshlrev_b32 v9, 4, v2
    s_lshl_b32 s27, s5, 12
    v_add_u32 v10, s27, v9
    ds_write_b128 v10, v[48:51] offset:0
    ds_write_b128 v10, v[64:67] offset:1024
    ds_write_b128 v10, v[80:83] offset:2048
    ds_write_b128 v10, v[96:99] offset:3072
    ds_write_b128 v10, v[52:55] offset:16384
    ds_write_b128 v10, v[68:71] offset:17408
    ds_write_b128 v10, v[84:87] offset:18432
    ds_write_b128 v10, v[100:103] offset:19456
    ds_write_b128 v10, v[56:59] offset:32768
    ds_write_b128 v10, v[72:75] offset:33792
    ds_write_b128 v10, v[88:91] offset:34816
    ds_write_b128 v10, v[104:107] offset:35840
    ds_write_b128 v10, v[60:63] offset:49152
    ds_write_b128 v10, v[76:79] offset:50176
    ds_write_b128 v10, v[92:95] offset:51200
    ds_write_b128 v10, v[108:111] offset:52224
    s_waitcnt lgkmcnt(0)
    s_barrier
    s_lshl_b32 s27, s5, 14
    v_add_u32 v10, s27, v9
    ds_read_b128 v[128:131], v10 offset:0
    ds_read_b128 v[132:135], v10 offset:1024
    ds_read_b128 v[136:139], v10 offset:2048
    ds_read_b128 v[140:143], v10 offset:3072
    ds_read_b128 v[144:147], v10 offset:4096
    ds_read_b128 v[148:151], v10 offset:5120
    ds_read_b128 v[152:155], v10 offset:6144
    ds_read_b128 v[156:159], v10 offset:7168
    ds_read_b128 v[160:163], v10 offset:8192
    ds_read_b128 v[164:167], v10 offset:9216
    ds_read_b128 v[168:171], v10 offset:10240
    ds_read_b128 v[172:175], v10 offset:11264
    ds_read_b128 v[176:179], v10 offset:12288
    ds_read_b128 v[180:183], v10 offset:13312
    ds_read_b128 v[184:187], v10 offset:14336
    ds_read_b128 v[188:191], v10 offset:15360
    s_waitcnt lgkmcnt(0)
    v_add_f32 v48, v128, v144
    v_add_f32 v64, v160, v176
    v_add_f32 v49, v129, v145
    v_add_f32 v65, v161, v177
    v_add_f32 v50, v130, v146
    v_add_f32 v66, v162, v178
    v_add_f32 v51, v131, v147
    v_add_f32 v67, v163, v179
    v_add_f32 v52, v132, v148
    v_add_f32 v68, v164, v180
    v_add_f32 v53, v133, v149
    v_add_f32 v69, v165, v181
    v_add_f32 v54, v134, v150
    v_add_f32 v70, v166, v182
    v_add_f32 v55, v135, v151
    v_add_f32 v71, v167, v183
    v_add_f32 v56, v136, v152
    v_add_f32 v72, v168, v184
    v_add_f32 v57, v137, v153
    v_add_f32 v73, v169, v185
    v_add_f32 v58, v138, v154
    v_add_f32 v74, v170, v186
    v_add_f32 v59, v139, v155
    v_add_f32 v75, v171, v187
    v_add_f32 v60, v140, v156
    v_add_f32 v76, v172, v188
    v_add_f32 v61, v141, v157
    v_add_f32 v77, v173, v189
    v_add_f32 v62, v142, v158
    v_add_f32 v78, v174, v190
    v_add_f32 v63, v143, v159
    v_add_f32 v79, v175, v191
    v_add_f32 v48, v48, v64
    v_add_f32 v49, v49, v65
    v_add_f32 v50, v50, v66
    v_add_f32 v51, v51, v67
    v_add_f32 v52, v52, v68
    v_add_f32 v53, v53, v69
    v_add_f32 v54, v54, v70
    v_add_f32 v55, v55, v71
    v_add_f32 v56, v56, v72
    v_add_f32 v57, v57, v73
    v_add_f32 v58, v58, v74
    v_add_f32 v59, v59, v75
    v_add_f32 v60, v60, v76
    v_add_f32 v61, v61, v77
    v_add_f32 v62, v62, v78
    v_add_f32 v63, v63, v79
    v_add_u32 v8, s24, v3
    s_lshl_b32 s27, s4, 8
    s_lshl_b32 s28, s5, 6
    s_add_u32 s27, s27, s28
    v_lshlrev_b32 v9, 5, v4
    v_add_u32 v9, s27, v9
    v_mul_u32_u24 v10, 1024, v8
    v_add_u32 v10, v10, v9
    s_add_u32 s28, s6, 0xa00000
    s_addc_u32 s29, s7, 0
    s_mov_b32 s30, 0x200000
    s_mov_b32 s31, 0x00020000
    buffer_load_dwordx4 v[24:27], v10, s[28:31], 0 offen
    buffer_load_dwordx4 v[28:31], v10, s[28:31], 0 offen offset:16
    s_waitcnt vmcnt(0)
    v_lshlrev_b32 v11, 16, v24
    v_add_f32 v48, v48, v11
    v_and_b32 v11, 0xffff0000, v24
    v_add_f32 v52, v52, v11
    v_lshlrev_b32 v11, 16, v25
    v_add_f32 v56, v56, v11
    v_and_b32 v11, 0xffff0000, v25
    v_add_f32 v60, v60, v11
    v_lshlrev_b32 v11, 16, v26
    v_add_f32 v49, v49, v11
    v_and_b32 v11, 0xffff0000, v26
    v_add_f32 v53, v53, v11
    v_lshlrev_b32 v11, 16, v27
    v_add_f32 v57, v57, v11
    v_and_b32 v11, 0xffff0000, v27
    v_add_f32 v61, v61, v11
    v_lshlrev_b32 v11, 16, v28
    v_add_f32 v50, v50, v11
    v_and_b32 v11, 0xffff0000, v28
    v_add_f32 v54, v54, v11
    v_lshlrev_b32 v11, 16, v29
    v_add_f32 v58, v58, v11
    v_and_b32 v11, 0xffff0000, v29
    v_add_f32 v62, v62, v11
    v_lshlrev_b32 v11, 16, v30
    v_add_f32 v51, v51, v11
    v_and_b32 v11, 0xffff0000, v30
    v_add_f32 v55, v55, v11
    v_lshlrev_b32 v11, 16, v31
    v_add_f32 v59, v59, v11
    v_and_b32 v11, 0xffff0000, v31
    v_add_f32 v63, v63, v11
    s_add_u32 s28, s6, 0xe00000
    s_addc_u32 s29, s7, 0
    s_mov_b32 s30, 0x200000
    s_mov_b32 s31, 0x00020000
    v_cvt_pk_bf16_f32 v16, v48, v52
    v_cvt_pk_bf16_f32 v17, v56, v60
    v_cvt_pk_bf16_f32 v18, v49, v53
    v_cvt_pk_bf16_f32 v19, v57, v61
    v_cvt_pk_bf16_f32 v20, v50, v54
    v_cvt_pk_bf16_f32 v21, v58, v62
    v_cvt_pk_bf16_f32 v22, v51, v55
    v_cvt_pk_bf16_f32 v23, v59, v63
    buffer_store_dwordx4 v[16:19], v10, s[28:31], 0 offen
    buffer_store_dwordx4 v[20:23], v10, s[28:31], 0 offen offset:16
L_end_k5_kernel:
    s_endpgm
.section .rodata,"a"
.p2align 6
.amdhsa_kernel k5_kernel
  .amdhsa_next_free_vgpr 256
  .amdhsa_next_free_sgpr 96
  .amdhsa_accum_offset 256
  .amdhsa_group_segment_fixed_size 0
  .amdhsa_kernarg_size 88
  .amdhsa_user_sgpr_count 2
  .amdhsa_user_sgpr_kernarg_segment_ptr 1
  .amdhsa_system_sgpr_workgroup_id_x 1
.end_amdhsa_kernel
.text

.globl k6_kernel
.p2align 8
.type k6_kernel,@function
k6_kernel:
    s_and_b32 s3, s2, 63
    s_lshr_b32 s4, s2, 6
    s_cmp_ge_u32 s4, 11
    s_cbranch_scc1 L_end_k6_kernel
    s_load_dwordx2 s[6:7], s[0:1], 80
    s_load_dwordx2 s[8:9], s[0:1], 48
    s_load_dwordx2 s[10:11], s[0:1], 0
    s_load_dwordx2 s[12:13], s[0:1], 64
    v_lshrrev_b32 v1, 6, v0
    v_and_b32 v2, 63, v0
    v_and_b32 v3, 31, v2
    v_lshrrev_b32 v4, 5, v2
    v_readfirstlane_b32 s5, v1
    s_mov_b32 s40, 0x05040100
    s_mov_b32 s41, 0x07060302
    s_waitcnt lgkmcnt(0)
    s_add_u32 s16, s6, 0xe00000
    s_addc_u32 s17, s7, 0
    s_mov_b32 s18, 0x200000
    s_mov_b32 s19, 0x00020000
    s_mov_b32 s20, s8
    s_mov_b32 s21, s9
    s_mov_b32 s22, 0x158000
    s_mov_b32 s23, 0x00020000
    s_lshl_b32 s24, s3, 5
    s_mul_i32 s25, s5, 8
    s_lshl_b32 s26, s4, 8
    s_mul_i32 s27, s25, 44032
    s_add_u32 s26, s26, s27
    v_mul_u32_u24 v5, 22016, v4
    v_lshl_add_u32 v5, v3, 3, v5
    v_lshrrev_b32 v6, 3, v0
    v_and_b32 v7, 7, v0
    v_add_u32 v8, s24, v6
    v_mul_u32_u24 v8, 1024, v8
    v_lshl_add_u32 v8, v7, 4, v8
    buffer_load_dwordx4 v[16:19], v8, s[16:19], 0 offen offset:0
    buffer_load_dwordx4 v[20:23], v8, s[16:19], 0 offen offset:128
    buffer_load_dwordx4 v[24:27], v8, s[16:19], 0 offen offset:256
    buffer_load_dwordx4 v[28:31], v8, s[16:19], 0 offen offset:384
    buffer_load_dwordx4 v[32:35], v8, s[16:19], 0 offen offset:512
    buffer_load_dwordx4 v[36:39], v8, s[16:19], 0 offen offset:640
    buffer_load_dwordx4 v[40:43], v8, s[16:19], 0 offen offset:768
    buffer_load_dwordx4 v[44:47], v8, s[16:19], 0 offen offset:896
    buffer_load_dwordx2 v[128:129], v5, s[20:23], s26 offen offset:0
    buffer_load_dwordx2 v[130:131], v5, s[20:23], s26 offen offset:2752
    s_add_u32 s28, s26, 0x1580
    buffer_load_dwordx2 v[132:133], v5, s[20:23], s28 offen
    s_add_u32 s28, s26, 0x2040
    buffer_load_dwordx2 v[134:135], v5, s[20:23], s28 offen
    s_add_u32 s28, s26, 0x2b00
    buffer_load_dwordx2 v[136:137], v5, s[20:23], s28 offen
    s_add_u32 s28, s26, 0x35c0
    buffer_load_dwordx2 v[138:139], v5, s[20:23], s28 offen
    s_add_u32 s28, s26, 0x4080
    buffer_load_dwordx2 v[140:141], v5, s[20:23], s28 offen
    s_add_u32 s28, s26, 0x4b40
    buffer_load_dwordx2 v[142:143], v5, s[20:23], s28 offen
    s_add_u32 s28, s26, 0xac00
    buffer_load_dwordx2 v[144:145], v5, s[20:23], s28 offen
    s_add_u32 s28, s26, 0xb6c0
    buffer_load_dwordx2 v[146:147], v5, s[20:23], s28 offen
    s_add_u32 s28, s26, 0xc180
    buffer_load_dwordx2 v[148:149], v5, s[20:23], s28 offen
    s_add_u32 s28, s26, 0xcc40
    buffer_load_dwordx2 v[150:151], v5, s[20:23], s28 offen
    s_add_u32 s28, s26, 0xd700
    buffer_load_dwordx2 v[152:153], v5, s[20:23], s28 offen
    s_add_u32 s28, s26, 0xe1c0
    buffer_load_dwordx2 v[154:155], v5, s[20:23], s28 offen
    s_add_u32 s28, s26, 0xec80
    buffer_load_dwordx2 v[156:157], v5, s[20:23], s28 offen
    s_add_u32 s28, s26, 0xf740
    buffer_load_dwordx2 v[158:159], v5, s[20:23], s28 offen
    s_add_u32 s28, s26, 0x15800
    buffer_load_dwordx2 v[160:161], v5, s[20:23], s28 offen
    s_add_u32 s28, s26, 0x162c0
    buffer_load_dwordx2 v[162:163], v5, s[20:23], s28 offen
    s_add_u32 s28, s26, 0x16d80
    buffer_load_dwordx2 v[164:165], v5, s[20:23], s28 offen
    s_add_u32 s28, s26, 0x17840
    buffer_load_dwordx2 v[166:167], v5, s[20:23], s28 offen
    s_add_u32 s28, s26, 0x18300
    buffer_load_dwordx2 v[168:169], v5, s[20:23], s28 offen
    s_add_u32 s28, s26, 0x18dc0
    buffer_load_dwordx2 v[170:171], v5, s[20:23], s28 offen
    s_add_u32 s28, s26, 0x19880
    buffer_load_dwordx2 v[172:173], v5, s[20:23], s28 offen
    s_add_u32 s28, s26, 0x1a340
    buffer_load_dwordx2 v[174:175], v5, s[20:23], s28 offen
    s_add_u32 s28, s26, 0x20400
    buffer_load_dwordx2 v[176:177], v5, s[20:23], s28 offen
    s_add_u32 s28, s26, 0x20ec0
    buffer_load_dwordx2 v[178:179], v5, s[20:23], s28 offen
    s_add_u32 s28, s26, 0x21980
    buffer_load_dwordx2 v[180:181], v5, s[20:23], s28 offen
    s_add_u32 s28, s26, 0x22440
    buffer_load_dwordx2 v[182:183], v5, s[20:23], s28 offen
    s_add_u32 s28, s26, 0x22f00
    buffer_load_dwordx2 v[184:185], v5, s[20:23], s28 offen
    s_add_u32 s28, s26, 0x239c0
    buffer_load_dwordx2 v[186:187], v5, s[20:23], s28 offen
    s_add_u32 s28, s26, 0x24480
    buffer_load_dwordx2 v[188:189], v5, s[20:23], s28 offen
    s_add_u32 s28, s26, 0x24f40
    buffer_load_dwordx2 v[190:191], v5, s[20:23], s28 offen
    s_waitcnt vmcnt(32)
    s_add_u32 s28, s26, 0x2b000
    buffer_load_dwordx2 v[192:193], v5, s[20:23], s28 offen
    s_add_u32 s28, s26, 0x2bac0
    buffer_load_dwordx2 v[194:195], v5, s[20:23], s28 offen
    s_add_u32 s28, s26, 0x2c580
    buffer_load_dwordx2 v[196:197], v5, s[20:23], s28 offen
    s_add_u32 s28, s26, 0x2d040
    buffer_load_dwordx2 v[198:199], v5, s[20:23], s28 offen
    s_add_u32 s28, s26, 0x2db00
    buffer_load_dwordx2 v[200:201], v5, s[20:23], s28 offen
    s_add_u32 s28, s26, 0x2e5c0
    buffer_load_dwordx2 v[202:203], v5, s[20:23], s28 offen
    s_add_u32 s28, s26, 0x2f080
    buffer_load_dwordx2 v[204:205], v5, s[20:23], s28 offen
    s_add_u32 s28, s26, 0x2fb40
    buffer_load_dwordx2 v[206:207], v5, s[20:23], s28 offen
    s_add_u32 s28, s26, 0x35c00
    buffer_load_dwordx2 v[208:209], v5, s[20:23], s28 offen
    s_add_u32 s28, s26, 0x366c0
    buffer_load_dwordx2 v[210:211], v5, s[20:23], s28 offen
    s_add_u32 s28, s26, 0x37180
    buffer_load_dwordx2 v[212:213], v5, s[20:23], s28 offen
    s_add_u32 s28, s26, 0x37c40
    buffer_load_dwordx2 v[214:215], v5, s[20:23], s28 offen
    s_add_u32 s28, s26, 0x38700
    buffer_load_dwordx2 v[216:217], v5, s[20:23], s28 offen
    s_add_u32 s28, s26, 0x391c0
    buffer_load_dwordx2 v[218:219], v5, s[20:23], s28 offen
    s_add_u32 s28, s26, 0x39c80
    buffer_load_dwordx2 v[220:221], v5, s[20:23], s28 offen
    s_add_u32 s28, s26, 0x3a740
    buffer_load_dwordx2 v[222:223], v5, s[20:23], s28 offen
    s_add_u32 s28, s26, 0x40800
    buffer_load_dwordx2 v[224:225], v5, s[20:23], s28 offen
    s_add_u32 s28, s26, 0x412c0
    buffer_load_dwordx2 v[226:227], v5, s[20:23], s28 offen
    s_add_u32 s28, s26, 0x41d80
    buffer_load_dwordx2 v[228:229], v5, s[20:23], s28 offen
    s_add_u32 s28, s26, 0x42840
    buffer_load_dwordx2 v[230:231], v5, s[20:23], s28 offen
    s_add_u32 s28, s26, 0x43300
    buffer_load_dwordx2 v[232:233], v5, s[20:23], s28 offen
    s_add_u32 s28, s26, 0x43dc0
    buffer_load_dwordx2 v[234:235], v5, s[20:23], s28 offen
    s_add_u32 s28, s26, 0x44880
    buffer_load_dwordx2 v[236:237], v5, s[20:23], s28 offen
    s_add_u32 s28, s26, 0x45340
    buffer_load_dwordx2 v[238:239], v5, s[20:23], s28 offen
    s_add_u32 s28, s26, 0x4b400
    buffer_load_dwordx2 v[240:241], v5, s[20:23], s28 offen
    s_add_u32 s28, s26, 0x4bec0
    buffer_load_dwordx2 v[242:243], v5, s[20:23], s28 offen
    s_add_u32 s28, s26, 0x4c980
    buffer_load_dwordx2 v[244:245], v5, s[20:23], s28 offen
    s_add_u32 s28, s26, 0x4d440
    buffer_load_dwordx2 v[246:247], v5, s[20:23], s28 offen
    s_add_u32 s28, s26, 0x4df00
    buffer_load_dwordx2 v[248:249], v5, s[20:23], s28 offen
    s_add_u32 s28, s26, 0x4e9c0
    buffer_load_dwordx2 v[250:251], v5, s[20:23], s28 offen
    s_add_u32 s28, s26, 0x4f480
    buffer_load_dwordx2 v[252:253], v5, s[20:23], s28 offen
    s_add_u32 s28, s26, 0x4ff40
    buffer_load_dwordx2 v[254:255], v5, s[20:23], s28 offen
    v_lshlrev_b32 v48, 16, v16
    v_and_b32 v49, 0xffff0000, v16
    v_lshlrev_b32 v50, 16, v17
    v_and_b32 v51, 0xffff0000, v17
    v_lshlrev_b32 v52, 16, v18
    v_and_b32 v53, 0xffff0000, v18
    v_lshlrev_b32 v54, 16, v19
    v_and_b32 v55, 0xffff0000, v19
    v_lshlrev_b32 v56, 16, v20
    v_and_b32 v57, 0xffff0000, v20
    v_lshlrev_b32 v58, 16, v21
    v_and_b32 v59, 0xffff0000, v21
    v_lshlrev_b32 v60, 16, v22
    v_and_b32 v61, 0xffff0000, v22
    v_lshlrev_b32 v62, 16, v23
    v_and_b32 v63, 0xffff0000, v23
    v_lshlrev_b32 v64, 16, v24
    v_and_b32 v65, 0xffff0000, v24
    v_lshlrev_b32 v66, 16, v25
    v_and_b32 v67, 0xffff0000, v25
    v_lshlrev_b32 v68, 16, v26
    v_and_b32 v69, 0xffff0000, v26
    v_lshlrev_b32 v70, 16, v27
    v_and_b32 v71, 0xffff0000, v27
    v_lshlrev_b32 v72, 16, v28
    v_and_b32 v73, 0xffff0000, v28
    v_lshlrev_b32 v74, 16, v29
    v_and_b32 v75, 0xffff0000, v29
    v_lshlrev_b32 v76, 16, v30
    v_and_b32 v77, 0xffff0000, v30
    v_lshlrev_b32 v78, 16, v31
    v_and_b32 v79, 0xffff0000, v31
    v_lshlrev_b32 v80, 16, v32
    v_and_b32 v81, 0xffff0000, v32
    v_lshlrev_b32 v82, 16, v33
    v_and_b32 v83, 0xffff0000, v33
    v_lshlrev_b32 v84, 16, v34
    v_and_b32 v85, 0xffff0000, v34
    v_lshlrev_b32 v86, 16, v35
    v_and_b32 v87, 0xffff0000, v35
    v_lshlrev_b32 v88, 16, v36
    v_and_b32 v89, 0xffff0000, v36
    v_lshlrev_b32 v90, 16, v37
    v_and_b32 v91, 0xffff0000, v37
    v_lshlrev_b32 v92, 16, v38
    v_and_b32 v93, 0xffff0000, v38
    v_lshlrev_b32 v94, 16, v39
    v_and_b32 v95, 0xffff0000, v39
    v_lshlrev_b32 v96, 16, v40
    v_and_b32 v97, 0xffff0000, v40
    v_lshlrev_b32 v98, 16, v41
    v_and_b32 v99, 0xffff0000, v41
    v_lshlrev_b32 v100, 16, v42
    v_and_b32 v101, 0xffff0000, v42
    v_lshlrev_b32 v102, 16, v43
    v_and_b32 v103, 0xffff0000, v43
    v_lshlrev_b32 v104, 16, v44
    v_and_b32 v105, 0xffff0000, v44
    v_lshlrev_b32 v106, 16, v45
    v_and_b32 v107, 0xffff0000, v45
    v_lshlrev_b32 v108, 16, v46
    v_and_b32 v109, 0xffff0000, v46
    v_lshlrev_b32 v110, 16, v47
    v_and_b32 v111, 0xffff0000, v47
    v_add_f32 v9, v48, v49
    v_add_f32 v9, v9, v50
    v_add_f32 v9, v9, v51
    v_add_f32 v9, v9, v52
    v_add_f32 v9, v9, v53
    v_add_f32 v9, v9, v54
    v_add_f32 v9, v9, v55
    v_add_f32 v9, v9, v56
    v_add_f32 v9, v9, v57
    v_add_f32 v9, v9, v58
    v_add_f32 v9, v9, v59
    v_add_f32 v9, v9, v60
    v_add_f32 v9, v9, v61
    v_add_f32 v9, v9, v62
    v_add_f32 v9, v9, v63
    v_add_f32 v9, v9, v64
    v_add_f32 v9, v9, v65
    v_add_f32 v9, v9, v66
    v_add_f32 v9, v9, v67
    v_add_f32 v9, v9, v68
    v_add_f32 v9, v9, v69
    v_add_f32 v9, v9, v70
    v_add_f32 v9, v9, v71
    v_add_f32 v9, v9, v72
    v_add_f32 v9, v9, v73
    v_add_f32 v9, v9, v74
    v_add_f32 v9, v9, v75
    v_add_f32 v9, v9, v76
    v_add_f32 v9, v9, v77
    v_add_f32 v9, v9, v78
    v_add_f32 v9, v9, v79
    v_add_f32 v9, v9, v80
    v_add_f32 v9, v9, v81
    v_add_f32 v9, v9, v82
    v_add_f32 v9, v9, v83
    v_add_f32 v9, v9, v84
    v_add_f32 v9, v9, v85
    v_add_f32 v9, v9, v86
    v_add_f32 v9, v9, v87
    v_add_f32 v9, v9, v88
    v_add_f32 v9, v9, v89
    v_add_f32 v9, v9, v90
    v_add_f32 v9, v9, v91
    v_add_f32 v9, v9, v92
    v_add_f32 v9, v9, v93
    v_add_f32 v9, v9, v94
    v_add_f32 v9, v9, v95
    v_add_f32 v9, v9, v96
    v_add_f32 v9, v9, v97
    v_add_f32 v9, v9, v98
    v_add_f32 v9, v9, v99
    v_add_f32 v9, v9, v100
    v_add_f32 v9, v9, v101
    v_add_f32 v9, v9, v102
    v_add_f32 v9, v9, v103
    v_add_f32 v9, v9, v104
    v_add_f32 v9, v9, v105
    v_add_f32 v9, v9, v106
    v_add_f32 v9, v9, v107
    v_add_f32 v9, v9, v108
    v_add_f32 v9, v9, v109
    v_add_f32 v9, v9, v110
    v_add_f32 v9, v9, v111
    s_nop 1
    v_add_f32_dpp v9, v9, v9 quad_perm:[1,0,3,2] row_mask:0xf bank_mask:0xf
    s_nop 1
    v_add_f32_dpp v9, v9, v9 quad_perm:[2,3,0,1] row_mask:0xf bank_mask:0xf
    s_nop 1
    v_add_f32_dpp v9, v9, v9 row_half_mirror row_mask:0xf bank_mask:0xf
    v_mul_f32 v9, 0x3b000000, v9
    v_sub_f32 v48, v48, v9
    v_sub_f32 v49, v49, v9
    v_sub_f32 v50, v50, v9
    v_sub_f32 v51, v51, v9
    v_sub_f32 v52, v52, v9
    v_sub_f32 v53, v53, v9
    v_sub_f32 v54, v54, v9
    v_sub_f32 v55, v55, v9
    v_sub_f32 v56, v56, v9
    v_sub_f32 v57, v57, v9
    v_sub_f32 v58, v58, v9
    v_sub_f32 v59, v59, v9
    v_sub_f32 v60, v60, v9
    v_sub_f32 v61, v61, v9
    v_sub_f32 v62, v62, v9
    v_sub_f32 v63, v63, v9
    v_sub_f32 v64, v64, v9
    v_sub_f32 v65, v65, v9
    v_sub_f32 v66, v66, v9
    v_sub_f32 v67, v67, v9
    v_sub_f32 v68, v68, v9
    v_sub_f32 v69, v69, v9
    v_sub_f32 v70, v70, v9
    v_sub_f32 v71, v71, v9
    v_sub_f32 v72, v72, v9
    v_sub_f32 v73, v73, v9
    v_sub_f32 v74, v74, v9
    v_sub_f32 v75, v75, v9
    v_sub_f32 v76, v76, v9
    v_sub_f32 v77, v77, v9
    v_sub_f32 v78, v78, v9
    v_sub_f32 v79, v79, v9
    v_sub_f32 v80, v80, v9
    v_sub_f32 v81, v81, v9
    v_sub_f32 v82, v82, v9
    v_sub_f32 v83, v83, v9
    v_sub_f32 v84, v84, v9
    v_sub_f32 v85, v85, v9
    v_sub_f32 v86, v86, v9
    v_sub_f32 v87, v87, v9
    v_sub_f32 v88, v88, v9
    v_sub_f32 v89, v89, v9
    v_sub_f32 v90, v90, v9
    v_sub_f32 v91, v91, v9
    v_sub_f32 v92, v92, v9
    v_sub_f32 v93, v93, v9
    v_sub_f32 v94, v94, v9
    v_sub_f32 v95, v95, v9
    v_sub_f32 v96, v96, v9
    v_sub_f32 v97, v97, v9
    v_sub_f32 v98, v98, v9
    v_sub_f32 v99, v99, v9
    v_sub_f32 v100, v100, v9
    v_sub_f32 v101, v101, v9
    v_sub_f32 v102, v102, v9
    v_sub_f32 v103, v103, v9
    v_sub_f32 v104, v104, v9
    v_sub_f32 v105, v105, v9
    v_sub_f32 v106, v106, v9
    v_sub_f32 v107, v107, v9
    v_sub_f32 v108, v108, v9
    v_sub_f32 v109, v109, v9
    v_sub_f32 v110, v110, v9
    v_sub_f32 v111, v111, v9
    v_mul_f32 v10, v48, v48
    v_fmac_f32 v10, v49, v49
    v_fmac_f32 v10, v50, v50
    v_fmac_f32 v10, v51, v51
    v_fmac_f32 v10, v52, v52
    v_fmac_f32 v10, v53, v53
    v_fmac_f32 v10, v54, v54
    v_fmac_f32 v10, v55, v55
    v_fmac_f32 v10, v56, v56
    v_fmac_f32 v10, v57, v57
    v_fmac_f32 v10, v58, v58
    v_fmac_f32 v10, v59, v59
    v_fmac_f32 v10, v60, v60
    v_fmac_f32 v10, v61, v61
    v_fmac_f32 v10, v62, v62
    v_fmac_f32 v10, v63, v63
    v_fmac_f32 v10, v64, v64
    v_fmac_f32 v10, v65, v65
    v_fmac_f32 v10, v66, v66
    v_fmac_f32 v10, v67, v67
    v_fmac_f32 v10, v68, v68
    v_fmac_f32 v10, v69, v69
    v_fmac_f32 v10, v70, v70
    v_fmac_f32 v10, v71, v71
    v_fmac_f32 v10, v72, v72
    v_fmac_f32 v10, v73, v73
    v_fmac_f32 v10, v74, v74
    v_fmac_f32 v10, v75, v75
    v_fmac_f32 v10, v76, v76
    v_fmac_f32 v10, v77, v77
    v_fmac_f32 v10, v78, v78
    v_fmac_f32 v10, v79, v79
    v_fmac_f32 v10, v80, v80
    v_fmac_f32 v10, v81, v81
    v_fmac_f32 v10, v82, v82
    v_fmac_f32 v10, v83, v83
    v_fmac_f32 v10, v84, v84
    v_fmac_f32 v10, v85, v85
    v_fmac_f32 v10, v86, v86
    v_fmac_f32 v10, v87, v87
    v_fmac_f32 v10, v88, v88
    v_fmac_f32 v10, v89, v89
    v_fmac_f32 v10, v90, v90
    v_fmac_f32 v10, v91, v91
    v_fmac_f32 v10, v92, v92
    v_fmac_f32 v10, v93, v93
    v_fmac_f32 v10, v94, v94
    v_fmac_f32 v10, v95, v95
    v_fmac_f32 v10, v96, v96
    v_fmac_f32 v10, v97, v97
    v_fmac_f32 v10, v98, v98
    v_fmac_f32 v10, v99, v99
    v_fmac_f32 v10, v100, v100
    v_fmac_f32 v10, v101, v101
    v_fmac_f32 v10, v102, v102
    v_fmac_f32 v10, v103, v103
    v_fmac_f32 v10, v104, v104
    v_fmac_f32 v10, v105, v105
    v_fmac_f32 v10, v106, v106
    v_fmac_f32 v10, v107, v107
    v_fmac_f32 v10, v108, v108
    v_fmac_f32 v10, v109, v109
    v_fmac_f32 v10, v110, v110
    v_fmac_f32 v10, v111, v111
    s_nop 1
    v_add_f32_dpp v10, v10, v10 quad_perm:[1,0,3,2] row_mask:0xf bank_mask:0xf
    s_nop 1
    v_add_f32_dpp v10, v10, v10 quad_perm:[2,3,0,1] row_mask:0xf bank_mask:0xf
    s_nop 1
    v_add_f32_dpp v10, v10, v10 row_half_mirror row_mask:0xf bank_mask:0xf
    v_mov_b32 v11, 0x3727c5ac
    v_fmac_f32 v11, 0x3b000000, v10
    v_rsq_f32 v11, v11
    s_nop 0
    v_mul_f32 v48, v48, v11
    v_mul_f32 v49, v49, v11
    v_mul_f32 v50, v50, v11
    v_mul_f32 v51, v51, v11
    v_mul_f32 v52, v52, v11
    v_mul_f32 v53, v53, v11
    v_mul_f32 v54, v54, v11
    v_mul_f32 v55, v55, v11
    v_mul_f32 v56, v56, v11
    v_mul_f32 v57, v57, v11
    v_mul_f32 v58, v58, v11
    v_mul_f32 v59, v59, v11
    v_mul_f32 v60, v60, v11
    v_mul_f32 v61, v61, v11
    v_mul_f32 v62, v62, v11
    v_mul_f32 v63, v63, v11
    v_mul_f32 v64, v64, v11
    v_mul_f32 v65, v65, v11
    v_mul_f32 v66, v66, v11
    v_mul_f32 v67, v67, v11
    v_mul_f32 v68, v68, v11
    v_mul_f32 v69, v69, v11
    v_mul_f32 v70, v70, v11
    v_mul_f32 v71, v71, v11
    v_mul_f32 v72, v72, v11
    v_mul_f32 v73, v73, v11
    v_mul_f32 v74, v74, v11
    v_mul_f32 v75, v75, v11
    v_mul_f32 v76, v76, v11
    v_mul_f32 v77, v77, v11
    v_mul_f32 v78, v78, v11
    v_mul_f32 v79, v79, v11
    v_mul_f32 v80, v80, v11
    v_mul_f32 v81, v81, v11
    v_mul_f32 v82, v82, v11
    v_mul_f32 v83, v83, v11
    v_mul_f32 v84, v84, v11
    v_mul_f32 v85, v85, v11
    v_mul_f32 v86, v86, v11
    v_mul_f32 v87, v87, v11
    v_mul_f32 v88, v88, v11
    v_mul_f32 v89, v89, v11
    v_mul_f32 v90, v90, v11
    v_mul_f32 v91, v91, v11
    v_mul_f32 v92, v92, v11
    v_mul_f32 v93, v93, v11
    v_mul_f32 v94, v94, v11
    v_mul_f32 v95, v95, v11
    v_mul_f32 v96, v96, v11
    v_mul_f32 v97, v97, v11
    v_mul_f32 v98, v98, v11
    v_mul_f32 v99, v99, v11
    v_mul_f32 v100, v100, v11
    v_mul_f32 v101, v101, v11
    v_mul_f32 v102, v102, v11
    v_mul_f32 v103, v103, v11
    v_mul_f32 v104, v104, v11
    v_mul_f32 v105, v105, v11
    v_mul_f32 v106, v106, v11
    v_mul_f32 v107, v107, v11
    v_mul_f32 v108, v108, v11
    v_mul_f32 v109, v109, v11
    v_mul_f32 v110, v110, v11
    v_mul_f32 v111, v111, v11
    v_cvt_pk_bf16_f32 v16, v48, v49
    v_cvt_pk_bf16_f32 v17, v50, v51
    v_cvt_pk_bf16_f32 v18, v52, v53
    v_cvt_pk_bf16_f32 v19, v54, v55
    v_cvt_pk_bf16_f32 v20, v56, v57
    v_cvt_pk_bf16_f32 v21, v58, v59
    v_cvt_pk_bf16_f32 v22, v60, v61
    v_cvt_pk_bf16_f32 v23, v62, v63
    v_cvt_pk_bf16_f32 v24, v64, v65
    v_cvt_pk_bf16_f32 v25, v66, v67
    v_cvt_pk_bf16_f32 v26, v68, v69
    v_cvt_pk_bf16_f32 v27, v70, v71
    v_cvt_pk_bf16_f32 v28, v72, v73
    v_cvt_pk_bf16_f32 v29, v74, v75
    v_cvt_pk_bf16_f32 v30, v76, v77
    v_cvt_pk_bf16_f32 v31, v78, v79
    v_cvt_pk_bf16_f32 v32, v80, v81
    v_cvt_pk_bf16_f32 v33, v82, v83
    v_cvt_pk_bf16_f32 v34, v84, v85
    v_cvt_pk_bf16_f32 v35, v86, v87
    v_cvt_pk_bf16_f32 v36, v88, v89
    v_cvt_pk_bf16_f32 v37, v90, v91
    v_cvt_pk_bf16_f32 v38, v92, v93
    v_cvt_pk_bf16_f32 v39, v94, v95
    v_cvt_pk_bf16_f32 v40, v96, v97
    v_cvt_pk_bf16_f32 v41, v98, v99
    v_cvt_pk_bf16_f32 v42, v100, v101
    v_cvt_pk_bf16_f32 v43, v102, v103
    v_cvt_pk_bf16_f32 v44, v104, v105
    v_cvt_pk_bf16_f32 v45, v106, v107
    v_cvt_pk_bf16_f32 v46, v108, v109
    v_cvt_pk_bf16_f32 v47, v110, v111
    v_mul_u32_u24 v9, 1040, v6
    v_lshl_add_u32 v9, v7, 4, v9
    ds_write_b128 v9, v[16:19] offset:0
    ds_write_b128 v9, v[20:23] offset:128
    ds_write_b128 v9, v[24:27] offset:256
    ds_write_b128 v9, v[28:31] offset:384
    ds_write_b128 v9, v[32:35] offset:512
    ds_write_b128 v9, v[36:39] offset:640
    ds_write_b128 v9, v[40:43] offset:768
    ds_write_b128 v9, v[44:47] offset:896
    s_waitcnt lgkmcnt(0)
    s_barrier
    v_mul_u32_u24 v9, 1040, v3
    v_lshl_add_u32 v9, v4, 4, v9
    s_lshl_b32 s27, s25, 5
    v_add_u32 v9, s27, v9
    v_mov_b32 v48, 0
    v_mov_b32 v49, 0
    v_mov_b32 v50, 0
    v_mov_b32 v51, 0
    v_mov_b32 v52, 0
    v_mov_b32 v53, 0
    v_mov_b32 v54, 0
    v_mov_b32 v55, 0
    v_mov_b32 v56, 0
    v_mov_b32 v57, 0
    v_mov_b32 v58, 0
    v_mov_b32 v59, 0
    v_mov_b32 v60, 0
    v_mov_b32 v61, 0
    v_mov_b32 v62, 0
    v_mov_b32 v63, 0
    v_mov_b32 v64, 0
    v_mov_b32 v65, 0
    v_mov_b32 v66, 0
    v_mov_b32 v67, 0
    v_mov_b32 v68, 0
    v_mov_b32 v69, 0
    v_mov_b32 v70, 0
    v_mov_b32 v71, 0
    v_mov_b32 v72, 0
    v_mov_b32 v73, 0
    v_mov_b32 v74, 0
    v_mov_b32 v75, 0
    v_mov_b32 v76, 0
    v_mov_b32 v77, 0
    v_mov_b32 v78, 0
    v_mov_b32 v79, 0
    v_mov_b32 v80, 0
    v_mov_b32 v81, 0
    v_mov_b32 v82, 0
    v_mov_b32 v83, 0
    v_mov_b32 v84, 0
    v_mov_b32 v85, 0
    v_mov_b32 v86, 0
    v_mov_b32 v87, 0
    v_mov_b32 v88, 0
    v_mov_b32 v89, 0
    v_mov_b32 v90, 0
    v_mov_b32 v91, 0
    v_mov_b32 v92, 0
    v_mov_b32 v93, 0
    v_mov_b32 v94, 0
    v_mov_b32 v95, 0
    v_mov_b32 v96, 0
    v_mov_b32 v97, 0
    v_mov_b32 v98, 0
    v_mov_b32 v99, 0
    v_mov_b32 v100, 0
    v_mov_b32 v101, 0
    v_mov_b32 v102, 0
    v_mov_b32 v103, 0
    v_mov_b32 v104, 0
    v_mov_b32 v105, 0
    v_mov_b32 v106, 0
    v_mov_b32 v107, 0
    v_mov_b32 v108, 0
    v_mov_b32 v109, 0
    v_mov_b32 v110, 0
    v_mov_b32 v111, 0
    ds_read_b128 v[40:43], v9 offset:0
    s_waitcnt vmcnt(32)
    v_perm_b32 v16, v130, v128, s40
    v_perm_b32 v17, v134, v132, s40
    v_perm_b32 v18, v138, v136, s40
    v_perm_b32 v19, v142, v140, s40
    v_perm_b32 v20, v130, v128, s41
    v_perm_b32 v21, v134, v132, s41
    v_perm_b32 v22, v138, v136, s41
    v_perm_b32 v23, v142, v140, s41
    v_perm_b32 v24, v131, v129, s40
    v_perm_b32 v25, v135, v133, s40
    v_perm_b32 v26, v139, v137, s40
    v_perm_b32 v27, v143, v141, s40
    v_perm_b32 v28, v131, v129, s41
    v_perm_b32 v29, v135, v133, s41
    v_perm_b32 v30, v139, v137, s41
    v_perm_b32 v31, v143, v141, s41
    s_waitcnt lgkmcnt(0)
    v_mfma_f32_32x32x16_bf16 v[48:63], v[16:19], v[40:43], v[48:63]
    v_mfma_f32_32x32x16_bf16 v[64:79], v[20:23], v[40:43], v[64:79]
    v_mfma_f32_32x32x16_bf16 v[80:95], v[24:27], v[40:43], v[80:95]
    v_mfma_f32_32x32x16_bf16 v[96:111], v[28:31], v[40:43], v[96:111]
    ds_read_b128 v[44:47], v9 offset:32
    v_perm_b32 v16, v146, v144, s40
    v_perm_b32 v17, v150, v148, s40
    v_perm_b32 v18, v154, v152, s40
    v_perm_b32 v19, v158, v156, s40
    v_perm_b32 v20, v146, v144, s41
    v_perm_b32 v21, v150, v148, s41
    v_perm_b32 v22, v154, v152, s41
    v_perm_b32 v23, v158, v156, s41
    v_perm_b32 v24, v147, v145, s40
    v_perm_b32 v25, v151, v149, s40
    v_perm_b32 v26, v155, v153, s40
    v_perm_b32 v27, v159, v157, s40
    v_perm_b32 v28, v147, v145, s41
    v_perm_b32 v29, v151, v149, s41
    v_perm_b32 v30, v155, v153, s41
    v_perm_b32 v31, v159, v157, s41
    s_waitcnt lgkmcnt(0)
    v_mfma_f32_32x32x16_bf16 v[48:63], v[16:19], v[44:47], v[48:63]
    v_mfma_f32_32x32x16_bf16 v[64:79], v[20:23], v[44:47], v[64:79]
    v_mfma_f32_32x32x16_bf16 v[80:95], v[24:27], v[44:47], v[80:95]
    v_mfma_f32_32x32x16_bf16 v[96:111], v[28:31], v[44:47], v[96:111]
    ds_read_b128 v[40:43], v9 offset:64
    v_perm_b32 v16, v162, v160, s40
    v_perm_b32 v17, v166, v164, s40
    v_perm_b32 v18, v170, v168, s40
    v_perm_b32 v19, v174, v172, s40
    v_perm_b32 v20, v162, v160, s41
    v_perm_b32 v21, v166, v164, s41
    v_perm_b32 v22, v170, v168, s41
    v_perm_b32 v23, v174, v172, s41
    v_perm_b32 v24, v163, v161, s40
    v_perm_b32 v25, v167, v165, s40
    v_perm_b32 v26, v171, v169, s40
    v_perm_b32 v27, v175, v173, s40
    v_perm_b32 v28, v163, v161, s41
    v_perm_b32 v29, v167, v165, s41
    v_perm_b32 v30, v171, v169, s41
    v_perm_b32 v31, v175, v173, s41
    s_waitcnt lgkmcnt(0)
    v_mfma_f32_32x32x16_bf16 v[48:63], v[16:19], v[40:43], v[48:63]
    v_mfma_f32_32x32x16_bf16 v[64:79], v[20:23], v[40:43], v[64:79]
    v_mfma_f32_32x32x16_bf16 v[80:95], v[24:27], v[40:43], v[80:95]
    v_mfma_f32_32x32x16_bf16 v[96:111], v[28:31], v[40:43], v[96:111]
    ds_read_b128 v[44:47], v9 offset:96
    v_perm_b32 v16, v178, v176, s40
    v_perm_b32 v17, v182, v180, s40
    v_perm_b32 v18, v186, v184, s40
    v_perm_b32 v19, v190, v188, s40
    v_perm_b32 v20, v178, v176, s41
    v_perm_b32 v21, v182, v180, s41
    v_perm_b32 v22, v186, v184, s41
    v_perm_b32 v23, v190, v188, s41
    v_perm_b32 v24, v179, v177, s40
    v_perm_b32 v25, v183, v181, s40
    v_perm_b32 v26, v187, v185, s40
    v_perm_b32 v27, v191, v189, s40
    v_perm_b32 v28, v179, v177, s41
    v_perm_b32 v29, v183, v181, s41
    v_perm_b32 v30, v187, v185, s41
    v_perm_b32 v31, v191, v189, s41
    s_waitcnt lgkmcnt(0)
    v_mfma_f32_32x32x16_bf16 v[48:63], v[16:19], v[44:47], v[48:63]
    v_mfma_f32_32x32x16_bf16 v[64:79], v[20:23], v[44:47], v[64:79]
    v_mfma_f32_32x32x16_bf16 v[80:95], v[24:27], v[44:47], v[80:95]
    v_mfma_f32_32x32x16_bf16 v[96:111], v[28:31], v[44:47], v[96:111]
    ds_read_b128 v[40:43], v9 offset:128
    s_waitcnt vmcnt(0)
    v_perm_b32 v16, v194, v192, s40
    v_perm_b32 v17, v198, v196, s40
    v_perm_b32 v18, v202, v200, s40
    v_perm_b32 v19, v206, v204, s40
    v_perm_b32 v20, v194, v192, s41
    v_perm_b32 v21, v198, v196, s41
    v_perm_b32 v22, v202, v200, s41
    v_perm_b32 v23, v206, v204, s41
    v_perm_b32 v24, v195, v193, s40
    v_perm_b32 v25, v199, v197, s40
    v_perm_b32 v26, v203, v201, s40
    v_perm_b32 v27, v207, v205, s40
    v_perm_b32 v28, v195, v193, s41
    v_perm_b32 v29, v199, v197, s41
    v_perm_b32 v30, v203, v201, s41
    v_perm_b32 v31, v207, v205, s41
    s_waitcnt lgkmcnt(0)
    v_mfma_f32_32x32x16_bf16 v[48:63], v[16:19], v[40:43], v[48:63]
    v_mfma_f32_32x32x16_bf16 v[64:79], v[20:23], v[40:43], v[64:79]
    v_mfma_f32_32x32x16_bf16 v[80:95], v[24:27], v[40:43], v[80:95]
    v_mfma_f32_32x32x16_bf16 v[96:111], v[28:31], v[40:43], v[96:111]
    ds_read_b128 v[44:47], v9 offset:160
    v_perm_b32 v16, v210, v208, s40
    v_perm_b32 v17, v214, v212, s40
    v_perm_b32 v18, v218, v216, s40
    v_perm_b32 v19, v222, v220, s40
    v_perm_b32 v20, v210, v208, s41
    v_perm_b32 v21, v214, v212, s41
    v_perm_b32 v22, v218, v216, s41
    v_perm_b32 v23, v222, v220, s41
    v_perm_b32 v24, v211, v209, s40
    v_perm_b32 v25, v215, v213, s40
    v_perm_b32 v26, v219, v217, s40
    v_perm_b32 v27, v223, v221, s40
    v_perm_b32 v28, v211, v209, s41
    v_perm_b32 v29, v215, v213, s41
    v_perm_b32 v30, v219, v217, s41
    v_perm_b32 v31, v223, v221, s41
    s_waitcnt lgkmcnt(0)
    v_mfma_f32_32x32x16_bf16 v[48:63], v[16:19], v[44:47], v[48:63]
    v_mfma_f32_32x32x16_bf16 v[64:79], v[20:23], v[44:47], v[64:79]
    v_mfma_f32_32x32x16_bf16 v[80:95], v[24:27], v[44:47], v[80:95]
    v_mfma_f32_32x32x16_bf16 v[96:111], v[28:31], v[44:47], v[96:111]
    ds_read_b128 v[40:43], v9 offset:192
    v_perm_b32 v16, v226, v224, s40
    v_perm_b32 v17, v230, v228, s40
    v_perm_b32 v18, v234, v232, s40
    v_perm_b32 v19, v238, v236, s40
    v_perm_b32 v20, v226, v224, s41
    v_perm_b32 v21, v230, v228, s41
    v_perm_b32 v22, v234, v232, s41
    v_perm_b32 v23, v238, v236, s41
    v_perm_b32 v24, v227, v225, s40
    v_perm_b32 v25, v231, v229, s40
    v_perm_b32 v26, v235, v233, s40
    v_perm_b32 v27, v239, v237, s40
    v_perm_b32 v28, v227, v225, s41
    v_perm_b32 v29, v231, v229, s41
    v_perm_b32 v30, v235, v233, s41
    v_perm_b32 v31, v239, v237, s41
    s_waitcnt lgkmcnt(0)
    v_mfma_f32_32x32x16_bf16 v[48:63], v[16:19], v[40:43], v[48:63]
    v_mfma_f32_32x32x16_bf16 v[64:79], v[20:23], v[40:43], v[64:79]
    v_mfma_f32_32x32x16_bf16 v[80:95], v[24:27], v[40:43], v[80:95]
    v_mfma_f32_32x32x16_bf16 v[96:111], v[28:31], v[40:43], v[96:111]
    ds_read_b128 v[44:47], v9 offset:224
    v_perm_b32 v16, v242, v240, s40
    v_perm_b32 v17, v246, v244, s40
    v_perm_b32 v18, v250, v248, s40
    v_perm_b32 v19, v254, v252, s40
    v_perm_b32 v20, v242, v240, s41
    v_perm_b32 v21, v246, v244, s41
    v_perm_b32 v22, v250, v248, s41
    v_perm_b32 v23, v254, v252, s41
    v_perm_b32 v24, v243, v241, s40
    v_perm_b32 v25, v247, v245, s40
    v_perm_b32 v26, v251, v249, s40
    v_perm_b32 v27, v255, v253, s40
    v_perm_b32 v28, v243, v241, s41
    v_perm_b32 v29, v247, v245, s41
    v_perm_b32 v30, v251, v249, s41
    v_perm_b32 v31, v255, v253, s41
    s_waitcnt lgkmcnt(0)
    v_mfma_f32_32x32x16_bf16 v[48:63], v[16:19], v[44:47], v[48:63]
    v_mfma_f32_32x32x16_bf16 v[64:79], v[20:23], v[44:47], v[64:79]
    v_mfma_f32_32x32x16_bf16 v[80:95], v[24:27], v[44:47], v[80:95]
    v_mfma_f32_32x32x16_bf16 v[96:111], v[28:31], v[44:47], v[96:111]
    s_nop 7
    s_nop 7
    s_waitcnt vmcnt(0)
    s_barrier
    v_lshlrev_b32 v9, 4, v2
    s_lshl_b32 s27, s5, 12
    v_add_u32 v10, s27, v9
    ds_write_b128 v10, v[48:51] offset:0
    ds_write_b128 v10, v[64:67] offset:1024
    ds_write_b128 v10, v[80:83] offset:2048
    ds_write_b128 v10, v[96:99] offset:3072
    ds_write_b128 v10, v[52:55] offset:16384
    ds_write_b128 v10, v[68:71] offset:17408
    ds_write_b128 v10, v[84:87] offset:18432
    ds_write_b128 v10, v[100:103] offset:19456
    ds_write_b128 v10, v[56:59] offset:32768
    ds_write_b128 v10, v[72:75] offset:33792
    ds_write_b128 v10, v[88:91] offset:34816
    ds_write_b128 v10, v[104:107] offset:35840
    ds_write_b128 v10, v[60:63] offset:49152
    ds_write_b128 v10, v[76:79] offset:50176
    ds_write_b128 v10, v[92:95] offset:51200
    ds_write_b128 v10, v[108:111] offset:52224
    s_waitcnt lgkmcnt(0)
    s_barrier
    s_lshl_b32 s27, s5, 14
    v_add_u32 v10, s27, v9
    ds_read_b128 v[128:131], v10 offset:0
    ds_read_b128 v[132:135], v10 offset:1024
    ds_read_b128 v[136:139], v10 offset:2048
    ds_read_b128 v[140:143], v10 offset:3072
    ds_read_b128 v[144:147], v10 offset:4096
    ds_read_b128 v[148:151], v10 offset:5120
    ds_read_b128 v[152:155], v10 offset:6144
    ds_read_b128 v[156:159], v10 offset:7168
    ds_read_b128 v[160:163], v10 offset:8192
    ds_read_b128 v[164:167], v10 offset:9216
    ds_read_b128 v[168:171], v10 offset:10240
    ds_read_b128 v[172:175], v10 offset:11264
    ds_read_b128 v[176:179], v10 offset:12288
    ds_read_b128 v[180:183], v10 offset:13312
    ds_read_b128 v[184:187], v10 offset:14336
    ds_read_b128 v[188:191], v10 offset:15360
    s_waitcnt lgkmcnt(0)
    v_add_f32 v48, v128, v144
    v_add_f32 v64, v160, v176
    v_add_f32 v49, v129, v145
    v_add_f32 v65, v161, v177
    v_add_f32 v50, v130, v146
    v_add_f32 v66, v162, v178
    v_add_f32 v51, v131, v147
    v_add_f32 v67, v163, v179
    v_add_f32 v52, v132, v148
    v_add_f32 v68, v164, v180
    v_add_f32 v53, v133, v149
    v_add_f32 v69, v165, v181
    v_add_f32 v54, v134, v150
    v_add_f32 v70, v166, v182
    v_add_f32 v55, v135, v151
    v_add_f32 v71, v167, v183
    v_add_f32 v56, v136, v152
    v_add_f32 v72, v168, v184
    v_add_f32 v57, v137, v153
    v_add_f32 v73, v169, v185
    v_add_f32 v58, v138, v154
    v_add_f32 v74, v170, v186
    v_add_f32 v59, v139, v155
    v_add_f32 v75, v171, v187
    v_add_f32 v60, v140, v156
    v_add_f32 v76, v172, v188
    v_add_f32 v61, v141, v157
    v_add_f32 v77, v173, v189
    v_add_f32 v62, v142, v158
    v_add_f32 v78, v174, v190
    v_add_f32 v63, v143, v159
    v_add_f32 v79, v175, v191
    v_add_f32 v48, v48, v64
    v_add_f32 v49, v49, v65
    v_add_f32 v50, v50, v66
    v_add_f32 v51, v51, v67
    v_add_f32 v52, v52, v68
    v_add_f32 v53, v53, v69
    v_add_f32 v54, v54, v70
    v_add_f32 v55, v55, v71
    v_add_f32 v56, v56, v72
    v_add_f32 v57, v57, v73
    v_add_f32 v58, v58, v74
    v_add_f32 v59, v59, v75
    v_add_f32 v60, v60, v76
    v_add_f32 v61, v61, v77
    v_add_f32 v62, v62, v78
    v_add_f32 v63, v63, v79
    v_add_u32 v8, s24, v3
    s_lshl_b32 s27, s4, 8
    s_lshl_b32 s28, s5, 6
    s_add_u32 s27, s27, s28
    v_lshlrev_b32 v9, 5, v4
    v_add_u32 v9, s27, v9
    s_mov_b32 s42, 0x3d372713
    s_mov_b32 s43, 0xc0135761
    v_mul_f32 v16, v48, v48
    v_fma_f32 v16, v16, s42, 1.0
    v_mul_f32 v16, v16, v48
    v_mul_f32 v16, s43, v16
    v_exp_f32 v16, v16
    s_nop 0
    v_add_f32 v16, 1.0, v16
    v_rcp_f32 v16, v16
    s_nop 0
    v_mul_f32 v48, v48, v16
    v_mul_f32 v16, v49, v49
    v_fma_f32 v16, v16, s42, 1.0
    v_mul_f32 v16, v16, v49
    v_mul_f32 v16, s43, v16
    v_exp_f32 v16, v16
    s_nop 0
    v_add_f32 v16, 1.0, v16
    v_rcp_f32 v16, v16
    s_nop 0
    v_mul_f32 v49, v49, v16
    v_mul_f32 v16, v50, v50
    v_fma_f32 v16, v16, s42, 1.0
    v_mul_f32 v16, v16, v50
    v_mul_f32 v16, s43, v16
    v_exp_f32 v16, v16
    s_nop 0
    v_add_f32 v16, 1.0, v16
    v_rcp_f32 v16, v16
    s_nop 0
    v_mul_f32 v50, v50, v16
    v_mul_f32 v16, v51, v51
    v_fma_f32 v16, v16, s42, 1.0
    v_mul_f32 v16, v16, v51
    v_mul_f32 v16, s43, v16
    v_exp_f32 v16, v16
    s_nop 0
    v_add_f32 v16, 1.0, v16
    v_rcp_f32 v16, v16
    s_nop 0
    v_mul_f32 v51, v51, v16
    v_mul_f32 v16, v52, v52
    v_fma_f32 v16, v16, s42, 1.0
    v_mul_f32 v16, v16, v52
    v_mul_f32 v16, s43, v16
    v_exp_f32 v16, v16
    s_nop 0
    v_add_f32 v16, 1.0, v16
    v_rcp_f32 v16, v16
    s_nop 0
    v_mul_f32 v52, v52, v16
    v_mul_f32 v16, v53, v53
    v_fma_f32 v16, v16, s42, 1.0
    v_mul_f32 v16, v16, v53
    v_mul_f32 v16, s43, v16
    v_exp_f32 v16, v16
    s_nop 0
    v_add_f32 v16, 1.0, v16
    v_rcp_f32 v16, v16
    s_nop 0
    v_mul_f32 v53, v53, v16
    v_mul_f32 v16, v54, v54
    v_fma_f32 v16, v16, s42, 1.0
    v_mul_f32 v16, v16, v54
    v_mul_f32 v16, s43, v16
    v_exp_f32 v16, v16
    s_nop 0
    v_add_f32 v16, 1.0, v16
    v_rcp_f32 v16, v16
    s_nop 0
    v_mul_f32 v54, v54, v16
    v_mul_f32 v16, v55, v55
    v_fma_f32 v16, v16, s42, 1.0
    v_mul_f32 v16, v16, v55
    v_mul_f32 v16, s43, v16
    v_exp_f32 v16, v16
    s_nop 0
    v_add_f32 v16, 1.0, v16
    v_rcp_f32 v16, v16
    s_nop 0
    v_mul_f32 v55, v55, v16
    v_mul_f32 v16, v56, v56
    v_fma_f32 v16, v16, s42, 1.0
    v_mul_f32 v16, v16, v56
    v_mul_f32 v16, s43, v16
    v_exp_f32 v16, v16
    s_nop 0
    v_add_f32 v16, 1.0, v16
    v_rcp_f32 v16, v16
    s_nop 0
    v_mul_f32 v56, v56, v16
    v_mul_f32 v16, v57, v57
    v_fma_f32 v16, v16, s42, 1.0
    v_mul_f32 v16, v16, v57
    v_mul_f32 v16, s43, v16
    v_exp_f32 v16, v16
    s_nop 0
    v_add_f32 v16, 1.0, v16
    v_rcp_f32 v16, v16
    s_nop 0
    v_mul_f32 v57, v57, v16
    v_mul_f32 v16, v58, v58
    v_fma_f32 v16, v16, s42, 1.0
    v_mul_f32 v16, v16, v58
    v_mul_f32 v16, s43, v16
    v_exp_f32 v16, v16
    s_nop 0
    v_add_f32 v16, 1.0, v16
    v_rcp_f32 v16, v16
    s_nop 0
    v_mul_f32 v58, v58, v16
    v_mul_f32 v16, v59, v59
    v_fma_f32 v16, v16, s42, 1.0
    v_mul_f32 v16, v16, v59
    v_mul_f32 v16, s43, v16
    v_exp_f32 v16, v16
    s_nop 0
    v_add_f32 v16, 1.0, v16
    v_rcp_f32 v16, v16
    s_nop 0
    v_mul_f32 v59, v59, v16
    v_mul_f32 v16, v60, v60
    v_fma_f32 v16, v16, s42, 1.0
    v_mul_f32 v16, v16, v60
    v_mul_f32 v16, s43, v16
    v_exp_f32 v16, v16
    s_nop 0
    v_add_f32 v16, 1.0, v16
    v_rcp_f32 v16, v16
    s_nop 0
    v_mul_f32 v60, v60, v16
    v_mul_f32 v16, v61, v61
    v_fma_f32 v16, v16, s42, 1.0
    v_mul_f32 v16, v16, v61
    v_mul_f32 v16, s43, v16
    v_exp_f32 v16, v16
    s_nop 0
    v_add_f32 v16, 1.0, v16
    v_rcp_f32 v16, v16
    s_nop 0
    v_mul_f32 v61, v61, v16
    v_mul_f32 v16, v62, v62
    v_fma_f32 v16, v16, s42, 1.0
    v_mul_f32 v16, v16, v62
    v_mul_f32 v16, s43, v16
    v_exp_f32 v16, v16
    s_nop 0
    v_add_f32 v16, 1.0, v16
    v_rcp_f32 v16, v16
    s_nop 0
    v_mul_f32 v62, v62, v16
    v_mul_f32 v16, v63, v63
    v_fma_f32 v16, v16, s42, 1.0
    v_mul_f32 v16, v16, v63
    v_mul_f32 v16, s43, v16
    v_exp_f32 v16, v16
    s_nop 0
    v_add_f32 v16, 1.0, v16
    v_rcp_f32 v16, v16
    s_nop 0
    v_mul_f32 v63, v63, v16
    v_mul_u32_u24 v10, 2752, v8
    v_add_u32 v10, v10, v9
    s_add_u32 s28, s6, 0x1000000
    s_addc_u32 s29, s7, 0
    s_mov_b32 s30, 0x560000
    s_mov_b32 s31, 0x00020000
    s_lshl_b32 s27, s4, 7
    s_lshl_b32 s32, s5, 5
    s_add_u32 s27, s27, s32
    s_cmp_ge_u32 s27, 1376
    s_cbranch_scc1 L_end_k6_kernel
    v_cvt_pk_bf16_f32 v16, v48, v52
    v_cvt_pk_bf16_f32 v17, v56, v60
    v_cvt_pk_bf16_f32 v18, v49, v53
    v_cvt_pk_bf16_f32 v19, v57, v61
    v_cvt_pk_bf16_f32 v20, v50, v54
    v_cvt_pk_bf16_f32 v21, v58, v62
    v_cvt_pk_bf16_f32 v22, v51, v55
    v_cvt_pk_bf16_f32 v23, v59, v63
    buffer_store_dwordx4 v[16:19], v10, s[28:31], 0 offen
    buffer_store_dwordx4 v[20:23], v10, s[28:31], 0 offen offset:16
L_end_k6_kernel:
    s_endpgm
.section .rodata,"a"
.p2align 6
.amdhsa_kernel k6_kernel
  .amdhsa_next_free_vgpr 256
  .amdhsa_next_free_sgpr 96
  .amdhsa_accum_offset 256
  .amdhsa_group_segment_fixed_size 0
  .amdhsa_kernarg_size 88
  .amdhsa_user_sgpr_count 2
  .amdhsa_user_sgpr_kernarg_segment_ptr 1
  .amdhsa_system_sgpr_workgroup_id_x 1
.end_amdhsa_kernel
.text

.globl k7_kernel
.p2align 8
.type k7_kernel,@function
k7_kernel:
    s_and_b32 s3, s2, 63
    s_lshr_b32 s4, s2, 6
    s_cmp_ge_u32 s4, 4
    s_cbranch_scc1 L_end_k7_kernel
    s_load_dwordx2 s[6:7], s[0:1], 80
    s_load_dwordx2 s[8:9], s[0:1], 56
    s_load_dwordx2 s[10:11], s[0:1], 0
    s_load_dwordx2 s[12:13], s[0:1], 64
    v_lshrrev_b32 v1, 6, v0
    v_and_b32 v2, 63, v0
    v_and_b32 v3, 31, v2
    v_lshrrev_b32 v4, 5, v2
    v_readfirstlane_b32 s5, v1
    s_mov_b32 s40, 0x05040100
    s_mov_b32 s41, 0x07060302
    s_waitcnt lgkmcnt(0)
    s_add_u32 s16, s6, 0x1000000
    s_addc_u32 s17, s7, 0
    s_mov_b32 s18, 0x560000
    s_mov_b32 s19, 0x00020000
    s_mov_b32 s20, s8
    s_mov_b32 s21, s9
    s_mov_b32 s22, 0x158000
    s_mov_b32 s23, 0x00020000
    s_lshl_b32 s24, s3, 5
    s_mul_i32 s25, s5, 21
    s_min_u32 s26, s5, 2
    s_add_u32 s25, s25, s26
    s_lshl_b32 s26, s4, 8
    s_mul_i32 s27, s25, 16384
    s_add_u32 s26, s26, s27
    v_mul_u32_u24 v5, 8192, v4
    v_lshl_add_u32 v5, v3, 3, v5
    v_add_u32 v8, s24, v3
    v_mul_u32_u24 v8, 2752, v8
    v_lshl_add_u32 v8, v4, 4, v8
    s_lshl_b32 s27, s25, 5
    v_add_u32 v12, s27, v8
    buffer_load_dwordx4 v[112:115], v12, s[16:19], 0 offen offset:0
    buffer_load_dwordx4 v[116:119], v12, s[16:19], 0 offen offset:32
    buffer_load_dwordx4 v[120:123], v12, s[16:19], 0 offen offset:64
    buffer_load_dwordx4 v[124:127], v12, s[16:19], 0 offen offset:96
    buffer_load_dwordx2 v[128:129], v5, s[20:23], s26 offen offset:0
    buffer_load_dwordx2 v[130:131], v5, s[20:23], s26 offen offset:1024
    buffer_load_dwordx2 v[132:133], v5, s[20:23], s26 offen offset:2048
    buffer_load_dwordx2 v[134:135], v5, s[20:23], s26 offen offset:3072
    s_add_u32 s28, s26, 0x1000
    buffer_load_dwordx2 v[136:137], v5, s[20:23], s28 offen
    s_add_u32 s28, s26, 0x1400
    buffer_load_dwordx2 v[138:139], v5, s[20:23], s28 offen
    s_add_u32 s28, s26, 0x1800
    buffer_load_dwordx2 v[140:141], v5, s[20:23], s28 offen
    s_add_u32 s28, s26, 0x1c00
    buffer_load_dwordx2 v[142:143], v5, s[20:23], s28 offen
    s_add_u32 s28, s26, 0x4000
    buffer_load_dwordx2 v[144:145], v5, s[20:23], s28 offen
    s_add_u32 s28, s26, 0x4400
    buffer_load_dwordx2 v[146:147], v5, s[20:23], s28 offen
    s_add_u32 s28, s26, 0x4800
    buffer_load_dwordx2 v[148:149], v5, s[20:23], s28 offen
    s_add_u32 s28, s26, 0x4c00
    buffer_load_dwordx2 v[150:151], v5, s[20:23], s28 offen
    s_add_u32 s28, s26, 0x5000
    buffer_load_dwordx2 v[152:153], v5, s[20:23], s28 offen
    s_add_u32 s28, s26, 0x5400
    buffer_load_dwordx2 v[154:155], v5, s[20:23], s28 offen
    s_add_u32 s28, s26, 0x5800
    buffer_load_dwordx2 v[156:157], v5, s[20:23], s28 offen
    s_add_u32 s28, s26, 0x5c00
    buffer_load_dwordx2 v[158:159], v5, s[20:23], s28 offen
    s_add_u32 s28, s26, 0x8000
    buffer_load_dwordx2 v[160:161], v5, s[20:23], s28 offen
    s_add_u32 s28, s26, 0x8400
    buffer_load_dwordx2 v[162:163], v5, s[20:23], s28 offen
    s_add_u32 s28, s26, 0x8800
    buffer_load_dwordx2 v[164:165], v5, s[20:23], s28 offen
    s_add_u32 s28, s26, 0x8c00
    buffer_load_dwordx2 v[166:167], v5, s[20:23], s28 offen
    s_add_u32 s28, s26, 0x9000
    buffer_load_dwordx2 v[168:169], v5, s[20:23], s28 offen
    s_add_u32 s28, s26, 0x9400
    buffer_load_dwordx2 v[170:171], v5, s[20:23], s28 offen
    s_add_u32 s28, s26, 0x9800
    buffer_load_dwordx2 v[172:173], v5, s[20:23], s28 offen
    s_add_u32 s28, s26, 0x9c00
    buffer_load_dwordx2 v[174:175], v5, s[20:23], s28 offen
    s_add_u32 s28, s26, 0xc000
    buffer_load_dwordx2 v[176:177], v5, s[20:23], s28 offen
    s_add_u32 s28, s26, 0xc400
    buffer_load_dwordx2 v[178:179], v5, s[20:23], s28 offen
    s_add_u32 s28, s26, 0xc800
    buffer_load_dwordx2 v[180:181], v5, s[20:23], s28 offen
    s_add_u32 s28, s26, 0xcc00
    buffer_load_dwordx2 v[182:183], v5, s[20:23], s28 offen
    s_add_u32 s28, s26, 0xd000
    buffer_load_dwordx2 v[184:185], v5, s[20:23], s28 offen
    s_add_u32 s28, s26, 0xd400
    buffer_load_dwordx2 v[186:187], v5, s[20:23], s28 offen
    s_add_u32 s28, s26, 0xd800
    buffer_load_dwordx2 v[188:189], v5, s[20:23], s28 offen
    s_add_u32 s28, s26, 0xdc00
    buffer_load_dwordx2 v[190:191], v5, s[20:23], s28 offen
    buffer_load_dwordx4 v[32:35], v12, s[16:19], 0 offen offset:128
    buffer_load_dwordx4 v[36:39], v12, s[16:19], 0 offen offset:160
    buffer_load_dwordx4 v[40:43], v12, s[16:19], 0 offen offset:192
    buffer_load_dwordx4 v[44:47], v12, s[16:19], 0 offen offset:224
    s_add_u32 s28, s26, 0x10000
    buffer_load_dwordx2 v[192:193], v5, s[20:23], s28 offen
    s_add_u32 s28, s26, 0x10400
    buffer_load_dwordx2 v[194:195], v5, s[20:23], s28 offen
    s_add_u32 s28, s26, 0x10800
    buffer_load_dwordx2 v[196:197], v5, s[20:23], s28 offen
    s_add_u32 s28, s26, 0x10c00
    buffer_load_dwordx2 v[198:199], v5, s[20:23], s28 offen
    s_add_u32 s28, s26, 0x11000
    buffer_load_dwordx2 v[200:201], v5, s[20:23], s28 offen
    s_add_u32 s28, s26, 0x11400
    buffer_load_dwordx2 v[202:203], v5, s[20:23], s28 offen
    s_add_u32 s28, s26, 0x11800
    buffer_load_dwordx2 v[204:205], v5, s[20:23], s28 offen
    s_add_u32 s28, s26, 0x11c00
    buffer_load_dwordx2 v[206:207], v5, s[20:23], s28 offen
    s_add_u32 s28, s26, 0x14000
    buffer_load_dwordx2 v[208:209], v5, s[20:23], s28 offen
    s_add_u32 s28, s26, 0x14400
    buffer_load_dwordx2 v[210:211], v5, s[20:23], s28 offen
    s_add_u32 s28, s26, 0x14800
    buffer_load_dwordx2 v[212:213], v5, s[20:23], s28 offen
    s_add_u32 s28, s26, 0x14c00
    buffer_load_dwordx2 v[214:215], v5, s[20:23], s28 offen
    s_add_u32 s28, s26, 0x15000
    buffer_load_dwordx2 v[216:217], v5, s[20:23], s28 offen
    s_add_u32 s28, s26, 0x15400
    buffer_load_dwordx2 v[218:219], v5, s[20:23], s28 offen
    s_add_u32 s28, s26, 0x15800
    buffer_load_dwordx2 v[220:221], v5, s[20:23], s28 offen
    s_add_u32 s28, s26, 0x15c00
    buffer_load_dwordx2 v[222:223], v5, s[20:23], s28 offen
    s_add_u32 s28, s26, 0x18000
    buffer_load_dwordx2 v[224:225], v5, s[20:23], s28 offen
    s_add_u32 s28, s26, 0x18400
    buffer_load_dwordx2 v[226:227], v5, s[20:23], s28 offen
    s_add_u32 s28, s26, 0x18800
    buffer_load_dwordx2 v[228:229], v5, s[20:23], s28 offen
    s_add_u32 s28, s26, 0x18c00
    buffer_load_dwordx2 v[230:231], v5, s[20:23], s28 offen
    s_add_u32 s28, s26, 0x19000
    buffer_load_dwordx2 v[232:233], v5, s[20:23], s28 offen
    s_add_u32 s28, s26, 0x19400
    buffer_load_dwordx2 v[234:235], v5, s[20:23], s28 offen
    s_add_u32 s28, s26, 0x19800
    buffer_load_dwordx2 v[236:237], v5, s[20:23], s28 offen
    s_add_u32 s28, s26, 0x19c00
    buffer_load_dwordx2 v[238:239], v5, s[20:23], s28 offen
    s_add_u32 s28, s26, 0x1c000
    buffer_load_dwordx2 v[240:241], v5, s[20:23], s28 offen
    s_add_u32 s28, s26, 0x1c400
    buffer_load_dwordx2 v[242:243], v5, s[20:23], s28 offen
    s_add_u32 s28, s26, 0x1c800
    buffer_load_dwordx2 v[244:245], v5, s[20:23], s28 offen
    s_add_u32 s28, s26, 0x1cc00
    buffer_load_dwordx2 v[246:247], v5, s[20:23], s28 offen
    s_add_u32 s28, s26, 0x1d000
    buffer_load_dwordx2 v[248:249], v5, s[20:23], s28 offen
    s_add_u32 s28, s26, 0x1d400
    buffer_load_dwordx2 v[250:251], v5, s[20:23], s28 offen
    s_add_u32 s28, s26, 0x1d800
    buffer_load_dwordx2 v[252:253], v5, s[20:23], s28 offen
    s_add_u32 s28, s26, 0x1dc00
    buffer_load_dwordx2 v[254:255], v5, s[20:23], s28 offen
    v_mov_b32 v48, 0
    v_mov_b32 v49, 0
    v_mov_b32 v50, 0
    v_mov_b32 v51, 0
    v_mov_b32 v52, 0
    v_mov_b32 v53, 0
    v_mov_b32 v54, 0
    v_mov_b32 v55, 0
    v_mov_b32 v56, 0
    v_mov_b32 v57, 0
    v_mov_b32 v58, 0
    v_mov_b32 v59, 0
    v_mov_b32 v60, 0
    v_mov_b32 v61, 0
    v_mov_b32 v62, 0
    v_mov_b32 v63, 0
    v_mov_b32 v64, 0
    v_mov_b32 v65, 0
    v_mov_b32 v66, 0
    v_mov_b32 v67, 0
    v_mov_b32 v68, 0
    v_mov_b32 v69, 0
    v_mov_b32 v70, 0
    v_mov_b32 v71, 0
    v_mov_b32 v72, 0
    v_mov_b32 v73, 0
    v_mov_b32 v74, 0
    v_mov_b32 v75, 0
    v_mov_b32 v76, 0
    v_mov_b32 v77, 0
    v_mov_b32 v78, 0
    v_mov_b32 v79, 0
    v_mov_b32 v80, 0
    v_mov_b32 v81, 0
    v_mov_b32 v82, 0
    v_mov_b32 v83, 0
    v_mov_b32 v84, 0
    v_mov_b32 v85, 0
    v_mov_b32 v86, 0
    v_mov_b32 v87, 0
    v_mov_b32 v88, 0
    v_mov_b32 v89, 0
    v_mov_b32 v90, 0
    v_mov_b32 v91, 0
    v_mov_b32 v92, 0
    v_mov_b32 v93, 0
    v_mov_b32 v94, 0
    v_mov_b32 v95, 0
    v_mov_b32 v96, 0
    v_mov_b32 v97, 0
    v_mov_b32 v98, 0
    v_mov_b32 v99, 0
    v_mov_b32 v100, 0
    v_mov_b32 v101, 0
    v_mov_b32 v102, 0
    v_mov_b32 v103, 0
    v_mov_b32 v104, 0
    v_mov_b32 v105, 0
    v_mov_b32 v106, 0
    v_mov_b32 v107, 0
    v_mov_b32 v108, 0
    v_mov_b32 v109, 0
    v_mov_b32 v110, 0
    v_mov_b32 v111, 0
    s_waitcnt vmcnt(36)
    v_perm_b32 v16, v130, v128, s40
    v_perm_b32 v17, v134, v132, s40
    v_perm_b32 v18, v138, v136, s40
    v_perm_b32 v19, v142, v140, s40
    v_perm_b32 v20, v130, v128, s41
    v_perm_b32 v21, v134, v132, s41
    v_perm_b32 v22, v138, v136, s41
    v_perm_b32 v23, v142, v140, s41
    v_perm_b32 v24, v131, v129, s40
    v_perm_b32 v25, v135, v133, s40
    v_perm_b32 v26, v139, v137, s40
    v_perm_b32 v27, v143, v141, s40
    v_perm_b32 v28, v131, v129, s41
    v_perm_b32 v29, v135, v133, s41
    v_perm_b32 v30, v139, v137, s41
    v_perm_b32 v31, v143, v141, s41
    s_nop 1
    v_mfma_f32_32x32x16_bf16 v[48:63], v[16:19], v[112:115], v[48:63]
    v_mfma_f32_32x32x16_bf16 v[64:79], v[20:23], v[112:115], v[64:79]
    v_mfma_f32_32x32x16_bf16 v[80:95], v[24:27], v[112:115], v[80:95]
    v_mfma_f32_32x32x16_bf16 v[96:111], v[28:31], v[112:115], v[96:111]
    v_perm_b32 v16, v146, v144, s40
    v_perm_b32 v17, v150, v148, s40
    v_perm_b32 v18, v154, v152, s40
    v_perm_b32 v19, v158, v156, s40
    v_perm_b32 v20, v146, v144, s41
    v_perm_b32 v21, v150, v148, s41
    v_perm_b32 v22, v154, v152, s41
    v_perm_b32 v23, v158, v156, s41
    v_perm_b32 v24, v147, v145, s40
    v_perm_b32 v25, v151, v149, s40
    v_perm_b32 v26, v155, v153, s40
    v_perm_b32 v27, v159, v157, s40
    v_perm_b32 v28, v147, v145, s41
    v_perm_b32 v29, v151, v149, s41
    v_perm_b32 v30, v155, v153, s41
    v_perm_b32 v31, v159, v157, s41
    s_nop 1
    v_mfma_f32_32x32x16_bf16 v[48:63], v[16:19], v[116:119], v[48:63]
    v_mfma_f32_32x32x16_bf16 v[64:79], v[20:23], v[116:119], v[64:79]
    v_mfma_f32_32x32x16_bf16 v[80:95], v[24:27], v[116:119], v[80:95]
    v_mfma_f32_32x32x16_bf16 v[96:111], v[28:31], v[116:119], v[96:111]
    v_perm_b32 v16, v162, v160, s40
    v_perm_b32 v17, v166, v164, s40
    v_perm_b32 v18, v170, v168, s40
    v_perm_b32 v19, v174, v172, s40
    v_perm_b32 v20, v162, v160, s41
    v_perm_b32 v21, v166, v164, s41
    v_perm_b32 v22, v170, v168, s41
    v_perm_b32 v23, v174, v172, s41
    v_perm_b32 v24, v163, v161, s40
    v_perm_b32 v25, v167, v165, s40
    v_perm_b32 v26, v171, v169, s40
    v_perm_b32 v27, v175, v173, s40
    v_perm_b32 v28, v163, v161, s41
    v_perm_b32 v29, v167, v165, s41
    v_perm_b32 v30, v171, v169, s41
    v_perm_b32 v31, v175, v173, s41
    s_nop 1
    v_mfma_f32_32x32x16_bf16 v[48:63], v[16:19], v[120:123], v[48:63]
    v_mfma_f32_32x32x16_bf16 v[64:79], v[20:23], v[120:123], v[64:79]
    v_mfma_f32_32x32x16_bf16 v[80:95], v[24:27], v[120:123], v[80:95]
    v_mfma_f32_32x32x16_bf16 v[96:111], v[28:31], v[120:123], v[96:111]
    v_perm_b32 v16, v178, v176, s40
    v_perm_b32 v17, v182, v180, s40
    v_perm_b32 v18, v186, v184, s40
    v_perm_b32 v19, v190, v188, s40
    v_perm_b32 v20, v178, v176, s41
    v_perm_b32 v21, v182, v180, s41
    v_perm_b32 v22, v186, v184, s41
    v_perm_b32 v23, v190, v188, s41
    v_perm_b32 v24, v179, v177, s40
    v_perm_b32 v25, v183, v181, s40
    v_perm_b32 v26, v187, v185, s40
    v_perm_b32 v27, v191, v189, s40
    v_perm_b32 v28, v179, v177, s41
    v_perm_b32 v29, v183, v181, s41
    v_perm_b32 v30, v187, v185, s41
    v_perm_b32 v31, v191, v189, s41
    s_nop 1
    v_mfma_f32_32x32x16_bf16 v[48:63], v[16:19], v[124:127], v[48:63]
    v_mfma_f32_32x32x16_bf16 v[64:79], v[20:23], v[124:127], v[64:79]
    v_mfma_f32_32x32x16_bf16 v[80:95], v[24:27], v[124:127], v[80:95]
    v_mfma_f32_32x32x16_bf16 v[96:111], v[28:31], v[124:127], v[96:111]
    buffer_load_dwordx4 v[112:115], v12, s[16:19], 0 offen offset:256
    buffer_load_dwordx4 v[116:119], v12, s[16:19], 0 offen offset:288
    buffer_load_dwordx4 v[120:123], v12, s[16:19], 0 offen offset:320
    buffer_load_dwordx4 v[124:127], v12, s[16:19], 0 offen offset:352
    s_add_u32 s28, s26, 0x20000
    buffer_load_dwordx2 v[128:129], v5, s[20:23], s28 offen
    s_add_u32 s28, s26, 0x20400
    buffer_load_dwordx2 v[130:131], v5, s[20:23], s28 offen
    s_add_u32 s28, s26, 0x20800
    buffer_load_dwordx2 v[132:133], v5, s[20:23], s28 offen
    s_add_u32 s28, s26, 0x20c00
    buffer_load_dwordx2 v[134:135], v5, s[20:23], s28 offen
    s_add_u32 s28, s26, 0x21000
    buffer_load_dwordx2 v[136:137], v5, s[20:23], s28 offen
    s_add_u32 s28, s26, 0x21400
    buffer_load_dwordx2 v[138:139], v5, s[20:23], s28 offen
    s_add_u32 s28, s26, 0x21800
    buffer_load_dwordx2 v[140:141], v5, s[20:23], s28 offen
    s_add_u32 s28, s26, 0x21c00
    buffer_load_dwordx2 v[142:143], v5, s[20:23], s28 offen
    s_add_u32 s28, s26, 0x24000
    buffer_load_dwordx2 v[144:145], v5, s[20:23], s28 offen
    s_add_u32 s28, s26, 0x24400
    buffer_load_dwordx2 v[146:147], v5, s[20:23], s28 offen
    s_add_u32 s28, s26, 0x24800
    buffer_load_dwordx2 v[148:149], v5, s[20:23], s28 offen
    s_add_u32 s28, s26, 0x24c00
    buffer_load_dwordx2 v[150:151], v5, s[20:23], s28 offen
    s_add_u32 s28, s26, 0x25000
    buffer_load_dwordx2 v[152:153], v5, s[20:23], s28 offen
    s_add_u32 s28, s26, 0x25400
    buffer_load_dwordx2 v[154:155], v5, s[20:23], s28 offen
    s_add_u32 s28, s26, 0x25800
    buffer_load_dwordx2 v[156:157], v5, s[20:23], s28 offen
    s_add_u32 s28, s26, 0x25c00
    buffer_load_dwordx2 v[158:159], v5, s[20:23], s28 offen
    s_add_u32 s28, s26, 0x28000
    buffer_load_dwordx2 v[160:161], v5, s[20:23], s28 offen
    s_add_u32 s28, s26, 0x28400
    buffer_load_dwordx2 v[162:163], v5, s[20:23], s28 offen
    s_add_u32 s28, s26, 0x28800
    buffer_load_dwordx2 v[164:165], v5, s[20:23], s28 offen
    s_add_u32 s28, s26, 0x28c00
    buffer_load_dwordx2 v[166:167], v5, s[20:23], s28 offen
    s_add_u32 s28, s26, 0x29000
    buffer_load_dwordx2 v[168:169], v5, s[20:23], s28 offen
    s_add_u32 s28, s26, 0x29400
    buffer_load_dwordx2 v[170:171], v5, s[20:23], s28 offen
    s_add_u32 s28, s26, 0x29800
    buffer_load_dwordx2 v[172:173], v5, s[20:23], s28 offen
    s_add_u32 s28, s26, 0x29c00
    buffer_load_dwordx2 v[174:175], v5, s[20:23], s28 offen
    s_add_u32 s28, s26, 0x2c000
    buffer_load_dwordx2 v[176:177], v5, s[20:23], s28 offen
    s_add_u32 s28, s26, 0x2c400
    buffer_load_dwordx2 v[178:179], v5, s[20:23], s28 offen
    s_add_u32 s28, s26, 0x2c800
    buffer_load_dwordx2 v[180:181], v5, s[20:23], s28 offen
    s_add_u32 s28, s26, 0x2cc00
    buffer_load_dwordx2 v[182:183], v5, s[20:23], s28 offen
    s_add_u32 s28, s26, 0x2d000
    buffer_load_dwordx2 v[184:185], v5, s[20:23], s28 offen
    s_add_u32 s28, s26, 0x2d400
    buffer_load_dwordx2 v[186:187], v5, s[20:23], s28 offen
    s_add_u32 s28, s26, 0x2d800
    buffer_load_dwordx2 v[188:189], v5, s[20:23], s28 offen
    s_add_u32 s28, s26, 0x2dc00
    buffer_load_dwordx2 v[190:191], v5, s[20:23], s28 offen
    s_waitcnt vmcnt(36)
    v_perm_b32 v16, v194, v192, s40
    v_perm_b32 v17, v198, v196, s40
    v_perm_b32 v18, v202, v200, s40
    v_perm_b32 v19, v206, v204, s40
    v_perm_b32 v20, v194, v192, s41
    v_perm_b32 v21, v198, v196, s41
    v_perm_b32 v22, v202, v200, s41
    v_perm_b32 v23, v206, v204, s41
    v_perm_b32 v24, v195, v193, s40
    v_perm_b32 v25, v199, v197, s40
    v_perm_b32 v26, v203, v201, s40
    v_perm_b32 v27, v207, v205, s40
    v_perm_b32 v28, v195, v193, s41
    v_perm_b32 v29, v199, v197, s41
    v_perm_b32 v30, v203, v201, s41
    v_perm_b32 v31, v207, v205, s41
    s_nop 1
    v_mfma_f32_32x32x16_bf16 v[48:63], v[16:19], v[32:35], v[48:63]
    v_mfma_f32_32x32x16_bf16 v[64:79], v[20:23], v[32:35], v[64:79]
    v_mfma_f32_32x32x16_bf16 v[80:95], v[24:27], v[32:35], v[80:95]
    v_mfma_f32_32x32x16_bf16 v[96:111], v[28:31], v[32:35], v[96:111]
    v_perm_b32 v16, v210, v208, s40
    v_perm_b32 v17, v214, v212, s40
    v_perm_b32 v18, v218, v216, s40
    v_perm_b32 v19, v222, v220, s40
    v_perm_b32 v20, v210, v208, s41
    v_perm_b32 v21, v214, v212, s41
    v_perm_b32 v22, v218, v216, s41
    v_perm_b32 v23, v222, v220, s41
    v_perm_b32 v24, v211, v209, s40
    v_perm_b32 v25, v215, v213, s40
    v_perm_b32 v26, v219, v217, s40
    v_perm_b32 v27, v223, v221, s40
    v_perm_b32 v28, v211, v209, s41
    v_perm_b32 v29, v215, v213, s41
    v_perm_b32 v30, v219, v217, s41
    v_perm_b32 v31, v223, v221, s41
    s_nop 1
    v_mfma_f32_32x32x16_bf16 v[48:63], v[16:19], v[36:39], v[48:63]
    v_mfma_f32_32x32x16_bf16 v[64:79], v[20:23], v[36:39], v[64:79]
    v_mfma_f32_32x32x16_bf16 v[80:95], v[24:27], v[36:39], v[80:95]
    v_mfma_f32_32x32x16_bf16 v[96:111], v[28:31], v[36:39], v[96:111]
    v_perm_b32 v16, v226, v224, s40
    v_perm_b32 v17, v230, v228, s40
    v_perm_b32 v18, v234, v232, s40
    v_perm_b32 v19, v238, v236, s40
    v_perm_b32 v20, v226, v224, s41
    v_perm_b32 v21, v230, v228, s41
    v_perm_b32 v22, v234, v232, s41
    v_perm_b32 v23, v238, v236, s41
    v_perm_b32 v24, v227, v225, s40
    v_perm_b32 v25, v231, v229, s40
    v_perm_b32 v26, v235, v233, s40
    v_perm_b32 v27, v239, v237, s40
    v_perm_b32 v28, v227, v225, s41
    v_perm_b32 v29, v231, v229, s41
    v_perm_b32 v30, v235, v233, s41
    v_perm_b32 v31, v239, v237, s41
    s_nop 1
    v_mfma_f32_32x32x16_bf16 v[48:63], v[16:19], v[40:43], v[48:63]
    v_mfma_f32_32x32x16_bf16 v[64:79], v[20:23], v[40:43], v[64:79]
    v_mfma_f32_32x32x16_bf16 v[80:95], v[24:27], v[40:43], v[80:95]
    v_mfma_f32_32x32x16_bf16 v[96:111], v[28:31], v[40:43], v[96:111]
    v_perm_b32 v16, v242, v240, s40
    v_perm_b32 v17, v246, v244, s40
    v_perm_b32 v18, v250, v248, s40
    v_perm_b32 v19, v254, v252, s40
    v_perm_b32 v20, v242, v240, s41
    v_perm_b32 v21, v246, v244, s41
    v_perm_b32 v22, v250, v248, s41
    v_perm_b32 v23, v254, v252, s41
    v_perm_b32 v24, v243, v241, s40
    v_perm_b32 v25, v247, v245, s40
    v_perm_b32 v26, v251, v249, s40
    v_perm_b32 v27, v255, v253, s40
    v_perm_b32 v28, v243, v241, s41
    v_perm_b32 v29, v247, v245, s41
    v_perm_b32 v30, v251, v249, s41
    v_perm_b32 v31, v255, v253, s41
    s_nop 1
    v_mfma_f32_32x32x16_bf16 v[48:63], v[16:19], v[44:47], v[48:63]
    v_mfma_f32_32x32x16_bf16 v[64:79], v[20:23], v[44:47], v[64:79]
    v_mfma_f32_32x32x16_bf16 v[80:95], v[24:27], v[44:47], v[80:95]
    v_mfma_f32_32x32x16_bf16 v[96:111], v[28:31], v[44:47], v[96:111]
    buffer_load_dwordx4 v[32:35], v12, s[16:19], 0 offen offset:384
    buffer_load_dwordx4 v[36:39], v12, s[16:19], 0 offen offset:416
    buffer_load_dwordx4 v[40:43], v12, s[16:19], 0 offen offset:448
    buffer_load_dwordx4 v[44:47], v12, s[16:19], 0 offen offset:480
    s_add_u32 s28, s26, 0x30000
    buffer_load_dwordx2 v[192:193], v5, s[20:23], s28 offen
    s_add_u32 s28, s26, 0x30400
    buffer_load_dwordx2 v[194:195], v5, s[20:23], s28 offen
    s_add_u32 s28, s26, 0x30800
    buffer_load_dwordx2 v[196:197], v5, s[20:23], s28 offen
    s_add_u32 s28, s26, 0x30c00
    buffer_load_dwordx2 v[198:199], v5, s[20:23], s28 offen
    s_add_u32 s28, s26, 0x31000
    buffer_load_dwordx2 v[200:201], v5, s[20:23], s28 offen
    s_add_u32 s28, s26, 0x31400
    buffer_load_dwordx2 v[202:203], v5, s[20:23], s28 offen
    s_add_u32 s28, s26, 0x31800
    buffer_load_dwordx2 v[204:205], v5, s[20:23], s28 offen
    s_add_u32 s28, s26, 0x31c00
    buffer_load_dwordx2 v[206:207], v5, s[20:23], s28 offen
    s_add_u32 s28, s26, 0x34000
    buffer_load_dwordx2 v[208:209], v5, s[20:23], s28 offen
    s_add_u32 s28, s26, 0x34400
    buffer_load_dwordx2 v[210:211], v5, s[20:23], s28 offen
    s_add_u32 s28, s26, 0x34800
    buffer_load_dwordx2 v[212:213], v5, s[20:23], s28 offen
    s_add_u32 s28, s26, 0x34c00
    buffer_load_dwordx2 v[214:215], v5, s[20:23], s28 offen
    s_add_u32 s28, s26, 0x35000
    buffer_load_dwordx2 v[216:217], v5, s[20:23], s28 offen
    s_add_u32 s28, s26, 0x35400
    buffer_load_dwordx2 v[218:219], v5, s[20:23], s28 offen
    s_add_u32 s28, s26, 0x35800
    buffer_load_dwordx2 v[220:221], v5, s[20:23], s28 offen
    s_add_u32 s28, s26, 0x35c00
    buffer_load_dwordx2 v[222:223], v5, s[20:23], s28 offen
    s_add_u32 s28, s26, 0x38000
    buffer_load_dwordx2 v[224:225], v5, s[20:23], s28 offen
    s_add_u32 s28, s26, 0x38400
    buffer_load_dwordx2 v[226:227], v5, s[20:23], s28 offen
    s_add_u32 s28, s26, 0x38800
    buffer_load_dwordx2 v[228:229], v5, s[20:23], s28 offen
    s_add_u32 s28, s26, 0x38c00
    buffer_load_dwordx2 v[230:231], v5, s[20:23], s28 offen
    s_add_u32 s28, s26, 0x39000
    buffer_load_dwordx2 v[232:233], v5, s[20:23], s28 offen
    s_add_u32 s28, s26, 0x39400
    buffer_load_dwordx2 v[234:235], v5, s[20:23], s28 offen
    s_add_u32 s28, s26, 0x39800
    buffer_load_dwordx2 v[236:237], v5, s[20:23], s28 offen
    s_add_u32 s28, s26, 0x39c00
    buffer_load_dwordx2 v[238:239], v5, s[20:23], s28 offen
    s_add_u32 s28, s26, 0x3c000
    buffer_load_dwordx2 v[240:241], v5, s[20:23], s28 offen
    s_add_u32 s28, s26, 0x3c400
    buffer_load_dwordx2 v[242:243], v5, s[20:23], s28 offen
    s_add_u32 s28, s26, 0x3c800
    buffer_load_dwordx2 v[244:245], v5, s[20:23], s28 offen
    s_add_u32 s28, s26, 0x3cc00
    buffer_load_dwordx2 v[246:247], v5, s[20:23], s28 offen
    s_add_u32 s28, s26, 0x3d000
    buffer_load_dwordx2 v[248:249], v5, s[20:23], s28 offen
    s_add_u32 s28, s26, 0x3d400
    buffer_load_dwordx2 v[250:251], v5, s[20:23], s28 offen
    s_add_u32 s28, s26, 0x3d800
    buffer_load_dwordx2 v[252:253], v5, s[20:23], s28 offen
    s_add_u32 s28, s26, 0x3dc00
    buffer_load_dwordx2 v[254:255], v5, s[20:23], s28 offen
    s_waitcnt vmcnt(36)
    v_perm_b32 v16, v130, v128, s40
    v_perm_b32 v17, v134, v132, s40
    v_perm_b32 v18, v138, v136, s40
    v_perm_b32 v19, v142, v140, s40
    v_perm_b32 v20, v130, v128, s41
    v_perm_b32 v21, v134, v132, s41
    v_perm_b32 v22, v138, v136, s41
    v_perm_b32 v23, v142, v140, s41
    v_perm_b32 v24, v131, v129, s40
    v_perm_b32 v25, v135, v133, s40
    v_perm_b32 v26, v139, v137, s40
    v_perm_b32 v27, v143, v141, s40
    v_perm_b32 v28, v131, v129, s41
    v_perm_b32 v29, v135, v133, s41
    v_perm_b32 v30, v139, v137, s41
    v_perm_b32 v31, v143, v141, s41
    s_nop 1
    v_mfma_f32_32x32x16_bf16 v[48:63], v[16:19], v[112:115], v[48:63]
    v_mfma_f32_32x32x16_bf16 v[64:79], v[20:23], v[112:115], v[64:79]
    v_mfma_f32_32x32x16_bf16 v[80:95], v[24:27], v[112:115], v[80:95]
    v_mfma_f32_32x32x16_bf16 v[96:111], v[28:31], v[112:115], v[96:111]
    v_perm_b32 v16, v146, v144, s40
    v_perm_b32 v17, v150, v148, s40
    v_perm_b32 v18, v154, v152, s40
    v_perm_b32 v19, v158, v156, s40
    v_perm_b32 v20, v146, v144, s41
    v_perm_b32 v21, v150, v148, s41
    v_perm_b32 v22, v154, v152, s41
    v_perm_b32 v23, v158, v156, s41
    v_perm_b32 v24, v147, v145, s40
    v_perm_b32 v25, v151, v149, s40
    v_perm_b32 v26, v155, v153, s40
    v_perm_b32 v27, v159, v157, s40
    v_perm_b32 v28, v147, v145, s41
    v_perm_b32 v29, v151, v149, s41
    v_perm_b32 v30, v155, v153, s41
    v_perm_b32 v31, v159, v157, s41
    s_nop 1
    v_mfma_f32_32x32x16_bf16 v[48:63], v[16:19], v[116:119], v[48:63]
    v_mfma_f32_32x32x16_bf16 v[64:79], v[20:23], v[116:119], v[64:79]
    v_mfma_f32_32x32x16_bf16 v[80:95], v[24:27], v[116:119], v[80:95]
    v_mfma_f32_32x32x16_bf16 v[96:111], v[28:31], v[116:119], v[96:111]
    v_perm_b32 v16, v162, v160, s40
    v_perm_b32 v17, v166, v164, s40
    v_perm_b32 v18, v170, v168, s40
    v_perm_b32 v19, v174, v172, s40
    v_perm_b32 v20, v162, v160, s41
    v_perm_b32 v21, v166, v164, s41
    v_perm_b32 v22, v170, v168, s41
    v_perm_b32 v23, v174, v172, s41
    v_perm_b32 v24, v163, v161, s40
    v_perm_b32 v25, v167, v165, s40
    v_perm_b32 v26, v171, v169, s40
    v_perm_b32 v27, v175, v173, s40
    v_perm_b32 v28, v163, v161, s41
    v_perm_b32 v29, v167, v165, s41
    v_perm_b32 v30, v171, v169, s41
    v_perm_b32 v31, v175, v173, s41
    s_nop 1
    v_mfma_f32_32x32x16_bf16 v[48:63], v[16:19], v[120:123], v[48:63]
    v_mfma_f32_32x32x16_bf16 v[64:79], v[20:23], v[120:123], v[64:79]
    v_mfma_f32_32x32x16_bf16 v[80:95], v[24:27], v[120:123], v[80:95]
    v_mfma_f32_32x32x16_bf16 v[96:111], v[28:31], v[120:123], v[96:111]
    v_perm_b32 v16, v178, v176, s40
    v_perm_b32 v17, v182, v180, s40
    v_perm_b32 v18, v186, v184, s40
    v_perm_b32 v19, v190, v188, s40
    v_perm_b32 v20, v178, v176, s41
    v_perm_b32 v21, v182, v180, s41
    v_perm_b32 v22, v186, v184, s41
    v_perm_b32 v23, v190, v188, s41
    v_perm_b32 v24, v179, v177, s40
    v_perm_b32 v25, v183, v181, s40
    v_perm_b32 v26, v187, v185, s40
    v_perm_b32 v27, v191, v189, s40
    v_perm_b32 v28, v179, v177, s41
    v_perm_b32 v29, v183, v181, s41
    v_perm_b32 v30, v187, v185, s41
    v_perm_b32 v31, v191, v189, s41
    s_nop 1
    v_mfma_f32_32x32x16_bf16 v[48:63], v[16:19], v[124:127], v[48:63]
    v_mfma_f32_32x32x16_bf16 v[64:79], v[20:23], v[124:127], v[64:79]
    v_mfma_f32_32x32x16_bf16 v[80:95], v[24:27], v[124:127], v[80:95]
    v_mfma_f32_32x32x16_bf16 v[96:111], v[28:31], v[124:127], v[96:111]
    buffer_load_dwordx4 v[112:115], v12, s[16:19], 0 offen offset:512
    buffer_load_dwordx4 v[116:119], v12, s[16:19], 0 offen offset:544
    buffer_load_dwordx4 v[120:123], v12, s[16:19], 0 offen offset:576
    buffer_load_dwordx4 v[124:127], v12, s[16:19], 0 offen offset:608
    s_add_u32 s28, s26, 0x40000
    buffer_load_dwordx2 v[128:129], v5, s[20:23], s28 offen
    s_add_u32 s28, s26, 0x40400
    buffer_load_dwordx2 v[130:131], v5, s[20:23], s28 offen
    s_add_u32 s28, s26, 0x40800
    buffer_load_dwordx2 v[132:133], v5, s[20:23], s28 offen
    s_add_u32 s28, s26, 0x40c00
    buffer_load_dwordx2 v[134:135], v5, s[20:23], s28 offen
    s_add_u32 s28, s26, 0x41000
    buffer_load_dwordx2 v[136:137], v5, s[20:23], s28 offen
    s_add_u32 s28, s26, 0x41400
    buffer_load_dwordx2 v[138:139], v5, s[20:23], s28 offen
    s_add_u32 s28, s26, 0x41800
    buffer_load_dwordx2 v[140:141], v5, s[20:23], s28 offen
    s_add_u32 s28, s26, 0x41c00
    buffer_load_dwordx2 v[142:143], v5, s[20:23], s28 offen
    s_add_u32 s28, s26, 0x44000
    buffer_load_dwordx2 v[144:145], v5, s[20:23], s28 offen
    s_add_u32 s28, s26, 0x44400
    buffer_load_dwordx2 v[146:147], v5, s[20:23], s28 offen
    s_add_u32 s28, s26, 0x44800
    buffer_load_dwordx2 v[148:149], v5, s[20:23], s28 offen
    s_add_u32 s28, s26, 0x44c00
    buffer_load_dwordx2 v[150:151], v5, s[20:23], s28 offen
    s_add_u32 s28, s26, 0x45000
    buffer_load_dwordx2 v[152:153], v5, s[20:23], s28 offen
    s_add_u32 s28, s26, 0x45400
    buffer_load_dwordx2 v[154:155], v5, s[20:23], s28 offen
    s_add_u32 s28, s26, 0x45800
    buffer_load_dwordx2 v[156:157], v5, s[20:23], s28 offen
    s_add_u32 s28, s26, 0x45c00
    buffer_load_dwordx2 v[158:159], v5, s[20:23], s28 offen
    s_add_u32 s28, s26, 0x48000
    buffer_load_dwordx2 v[160:161], v5, s[20:23], s28 offen
    s_add_u32 s28, s26, 0x48400
    buffer_load_dwordx2 v[162:163], v5, s[20:23], s28 offen
    s_add_u32 s28, s26, 0x48800
    buffer_load_dwordx2 v[164:165], v5, s[20:23], s28 offen
    s_add_u32 s28, s26, 0x48c00
    buffer_load_dwordx2 v[166:167], v5, s[20:23], s28 offen
    s_add_u32 s28, s26, 0x49000
    buffer_load_dwordx2 v[168:169], v5, s[20:23], s28 offen
    s_add_u32 s28, s26, 0x49400
    buffer_load_dwordx2 v[170:171], v5, s[20:23], s28 offen
    s_add_u32 s28, s26, 0x49800
    buffer_load_dwordx2 v[172:173], v5, s[20:23], s28 offen
    s_add_u32 s28, s26, 0x49c00
    buffer_load_dwordx2 v[174:175], v5, s[20:23], s28 offen
    s_add_u32 s28, s26, 0x4c000
    buffer_load_dwordx2 v[176:177], v5, s[20:23], s28 offen
    s_add_u32 s28, s26, 0x4c400
    buffer_load_dwordx2 v[178:179], v5, s[20:23], s28 offen
    s_add_u32 s28, s26, 0x4c800
    buffer_load_dwordx2 v[180:181], v5, s[20:23], s28 offen
    s_add_u32 s28, s26, 0x4cc00
    buffer_load_dwordx2 v[182:183], v5, s[20:23], s28 offen
    s_add_u32 s28, s26, 0x4d000
    buffer_load_dwordx2 v[184:185], v5, s[20:23], s28 offen
    s_add_u32 s28, s26, 0x4d400
    buffer_load_dwordx2 v[186:187], v5, s[20:23], s28 offen
    s_add_u32 s28, s26, 0x4d800
    buffer_load_dwordx2 v[188:189], v5, s[20:23], s28 offen
    s_add_u32 s28, s26, 0x4dc00
    buffer_load_dwordx2 v[190:191], v5, s[20:23], s28 offen
    s_waitcnt vmcnt(36)
    v_perm_b32 v16, v194, v192, s40
    v_perm_b32 v17, v198, v196, s40
    v_perm_b32 v18, v202, v200, s40
    v_perm_b32 v19, v206, v204, s40
    v_perm_b32 v20, v194, v192, s41
    v_perm_b32 v21, v198, v196, s41
    v_perm_b32 v22, v202, v200, s41
    v_perm_b32 v23, v206, v204, s41
    v_perm_b32 v24, v195, v193, s40
    v_perm_b32 v25, v199, v197, s40
    v_perm_b32 v26, v203, v201, s40
    v_perm_b32 v27, v207, v205, s40
    v_perm_b32 v28, v195, v193, s41
    v_perm_b32 v29, v199, v197, s41
    v_perm_b32 v30, v203, v201, s41
    v_perm_b32 v31, v207, v205, s41
    s_nop 1
    v_mfma_f32_32x32x16_bf16 v[48:63], v[16:19], v[32:35], v[48:63]
    v_mfma_f32_32x32x16_bf16 v[64:79], v[20:23], v[32:35], v[64:79]
    v_mfma_f32_32x32x16_bf16 v[80:95], v[24:27], v[32:35], v[80:95]
    v_mfma_f32_32x32x16_bf16 v[96:111], v[28:31], v[32:35], v[96:111]
    v_perm_b32 v16, v210, v208, s40
    v_perm_b32 v17, v214, v212, s40
    v_perm_b32 v18, v218, v216, s40
    v_perm_b32 v19, v222, v220, s40
    v_perm_b32 v20, v210, v208, s41
    v_perm_b32 v21, v214, v212, s41
    v_perm_b32 v22, v218, v216, s41
    v_perm_b32 v23, v222, v220, s41
    v_perm_b32 v24, v211, v209, s40
    v_perm_b32 v25, v215, v213, s40
    v_perm_b32 v26, v219, v217, s40
    v_perm_b32 v27, v223, v221, s40
    v_perm_b32 v28, v211, v209, s41
    v_perm_b32 v29, v215, v213, s41
    v_perm_b32 v30, v219, v217, s41
    v_perm_b32 v31, v223, v221, s41
    s_nop 1
    v_mfma_f32_32x32x16_bf16 v[48:63], v[16:19], v[36:39], v[48:63]
    v_mfma_f32_32x32x16_bf16 v[64:79], v[20:23], v[36:39], v[64:79]
    v_mfma_f32_32x32x16_bf16 v[80:95], v[24:27], v[36:39], v[80:95]
    v_mfma_f32_32x32x16_bf16 v[96:111], v[28:31], v[36:39], v[96:111]
    v_perm_b32 v16, v226, v224, s40
    v_perm_b32 v17, v230, v228, s40
    v_perm_b32 v18, v234, v232, s40
    v_perm_b32 v19, v238, v236, s40
    v_perm_b32 v20, v226, v224, s41
    v_perm_b32 v21, v230, v228, s41
    v_perm_b32 v22, v234, v232, s41
    v_perm_b32 v23, v238, v236, s41
    v_perm_b32 v24, v227, v225, s40
    v_perm_b32 v25, v231, v229, s40
    v_perm_b32 v26, v235, v233, s40
    v_perm_b32 v27, v239, v237, s40
    v_perm_b32 v28, v227, v225, s41
    v_perm_b32 v29, v231, v229, s41
    v_perm_b32 v30, v235, v233, s41
    v_perm_b32 v31, v239, v237, s41
    s_nop 1
    v_mfma_f32_32x32x16_bf16 v[48:63], v[16:19], v[40:43], v[48:63]
    v_mfma_f32_32x32x16_bf16 v[64:79], v[20:23], v[40:43], v[64:79]
    v_mfma_f32_32x32x16_bf16 v[80:95], v[24:27], v[40:43], v[80:95]
    v_mfma_f32_32x32x16_bf16 v[96:111], v[28:31], v[40:43], v[96:111]
    v_perm_b32 v16, v242, v240, s40
    v_perm_b32 v17, v246, v244, s40
    v_perm_b32 v18, v250, v248, s40
    v_perm_b32 v19, v254, v252, s40
    v_perm_b32 v20, v242, v240, s41
    v_perm_b32 v21, v246, v244, s41
    v_perm_b32 v22, v250, v248, s41
    v_perm_b32 v23, v254, v252, s41
    v_perm_b32 v24, v243, v241, s40
    v_perm_b32 v25, v247, v245, s40
    v_perm_b32 v26, v251, v249, s40
    v_perm_b32 v27, v255, v253, s40
    v_perm_b32 v28, v243, v241, s41
    v_perm_b32 v29, v247, v245, s41
    v_perm_b32 v30, v251, v249, s41
    v_perm_b32 v31, v255, v253, s41
    s_nop 1
    v_mfma_f32_32x32x16_bf16 v[48:63], v[16:19], v[44:47], v[48:63]
    v_mfma_f32_32x32x16_bf16 v[64:79], v[20:23], v[44:47], v[64:79]
    v_mfma_f32_32x32x16_bf16 v[80:95], v[24:27], v[44:47], v[80:95]
    v_mfma_f32_32x32x16_bf16 v[96:111], v[28:31], v[44:47], v[96:111]
    buffer_load_dwordx4 v[32:35], v12, s[16:19], 0 offen offset:640
    buffer_load_dwordx4 v[36:39], v12, s[16:19], 0 offen offset:672
    s_add_u32 s28, s26, 0x50000
    buffer_load_dwordx2 v[192:193], v5, s[20:23], s28 offen
    s_add_u32 s28, s26, 0x50400
    buffer_load_dwordx2 v[194:195], v5, s[20:23], s28 offen
    s_add_u32 s28, s26, 0x50800
    buffer_load_dwordx2 v[196:197], v5, s[20:23], s28 offen
    s_add_u32 s28, s26, 0x50c00
    buffer_load_dwordx2 v[198:199], v5, s[20:23], s28 offen
    s_add_u32 s28, s26, 0x51000
    buffer_load_dwordx2 v[200:201], v5, s[20:23], s28 offen
    s_add_u32 s28, s26, 0x51400
    buffer_load_dwordx2 v[202:203], v5, s[20:23], s28 offen
    s_add_u32 s28, s26, 0x51800
    buffer_load_dwordx2 v[204:205], v5, s[20:23], s28 offen
    s_add_u32 s28, s26, 0x51c00
    buffer_load_dwordx2 v[206:207], v5, s[20:23], s28 offen
    s_add_u32 s28, s26, 0x54000
    buffer_load_dwordx2 v[208:209], v5, s[20:23], s28 offen
    s_add_u32 s28, s26, 0x54400
    buffer_load_dwordx2 v[210:211], v5, s[20:23], s28 offen
    s_add_u32 s28, s26, 0x54800
    buffer_load_dwordx2 v[212:213], v5, s[20:23], s28 offen
    s_add_u32 s28, s26, 0x54c00
    buffer_load_dwordx2 v[214:215], v5, s[20:23], s28 offen
    s_add_u32 s28, s26, 0x55000
    buffer_load_dwordx2 v[216:217], v5, s[20:23], s28 offen
    s_add_u32 s28, s26, 0x55400
    buffer_load_dwordx2 v[218:219], v5, s[20:23], s28 offen
    s_add_u32 s28, s26, 0x55800
    buffer_load_dwordx2 v[220:221], v5, s[20:23], s28 offen
    s_add_u32 s28, s26, 0x55c00
    buffer_load_dwordx2 v[222:223], v5, s[20:23], s28 offen
    s_waitcnt vmcnt(18)
    v_perm_b32 v16, v130, v128, s40
    v_perm_b32 v17, v134, v132, s40
    v_perm_b32 v18, v138, v136, s40
    v_perm_b32 v19, v142, v140, s40
    v_perm_b32 v20, v130, v128, s41
    v_perm_b32 v21, v134, v132, s41
    v_perm_b32 v22, v138, v136, s41
    v_perm_b32 v23, v142, v140, s41
    v_perm_b32 v24, v131, v129, s40
    v_perm_b32 v25, v135, v133, s40
    v_perm_b32 v26, v139, v137, s40
    v_perm_b32 v27, v143, v141, s40
    v_perm_b32 v28, v131, v129, s41
    v_perm_b32 v29, v135, v133, s41
    v_perm_b32 v30, v139, v137, s41
    v_perm_b32 v31, v143, v141, s41
    s_nop 1
    v_mfma_f32_32x32x16_bf16 v[48:63], v[16:19], v[112:115], v[48:63]
    v_mfma_f32_32x32x16_bf16 v[64:79], v[20:23], v[112:115], v[64:79]
    v_mfma_f32_32x32x16_bf16 v[80:95], v[24:27], v[112:115], v[80:95]
    v_mfma_f32_32x32x16_bf16 v[96:111], v[28:31], v[112:115], v[96:111]
    v_perm_b32 v16, v146, v144, s40
    v_perm_b32 v17, v150, v148, s40
    v_perm_b32 v18, v154, v152, s40
    v_perm_b32 v19, v158, v156, s40
    v_perm_b32 v20, v146, v144, s41
    v_perm_b32 v21, v150, v148, s41
    v_perm_b32 v22, v154, v152, s41
    v_perm_b32 v23, v158, v156, s41
    v_perm_b32 v24, v147, v145, s40
    v_perm_b32 v25, v151, v149, s40
    v_perm_b32 v26, v155, v153, s40
    v_perm_b32 v27, v159, v157, s40
    v_perm_b32 v28, v147, v145, s41
    v_perm_b32 v29, v151, v149, s41
    v_perm_b32 v30, v155, v153, s41
    v_perm_b32 v31, v159, v157, s41
    s_nop 1
    v_mfma_f32_32x32x16_bf16 v[48:63], v[16:19], v[116:119], v[48:63]
    v_mfma_f32_32x32x16_bf16 v[64:79], v[20:23], v[116:119], v[64:79]
    v_mfma_f32_32x32x16_bf16 v[80:95], v[24:27], v[116:119], v[80:95]
    v_mfma_f32_32x32x16_bf16 v[96:111], v[28:31], v[116:119], v[96:111]
    v_perm_b32 v16, v162, v160, s40
    v_perm_b32 v17, v166, v164, s40
    v_perm_b32 v18, v170, v168, s40
    v_perm_b32 v19, v174, v172, s40
    v_perm_b32 v20, v162, v160, s41
    v_perm_b32 v21, v166, v164, s41
    v_perm_b32 v22, v170, v168, s41
    v_perm_b32 v23, v174, v172, s41
    v_perm_b32 v24, v163, v161, s40
    v_perm_b32 v25, v167, v165, s40
    v_perm_b32 v26, v171, v169, s40
    v_perm_b32 v27, v175, v173, s40
    v_perm_b32 v28, v163, v161, s41
    v_perm_b32 v29, v167, v165, s41
    v_perm_b32 v30, v171, v169, s41
    v_perm_b32 v31, v175, v173, s41
    s_nop 1
    v_mfma_f32_32x32x16_bf16 v[48:63], v[16:19], v[120:123], v[48:63]
    v_mfma_f32_32x32x16_bf16 v[64:79], v[20:23], v[120:123], v[64:79]
    v_mfma_f32_32x32x16_bf16 v[80:95], v[24:27], v[120:123], v[80:95]
    v_mfma_f32_32x32x16_bf16 v[96:111], v[28:31], v[120:123], v[96:111]
    v_perm_b32 v16, v178, v176, s40
    v_perm_b32 v17, v182, v180, s40
    v_perm_b32 v18, v186, v184, s40
    v_perm_b32 v19, v190, v188, s40
    v_perm_b32 v20, v178, v176, s41
    v_perm_b32 v21, v182, v180, s41
    v_perm_b32 v22, v186, v184, s41
    v_perm_b32 v23, v190, v188, s41
    v_perm_b32 v24, v179, v177, s40
    v_perm_b32 v25, v183, v181, s40
    v_perm_b32 v26, v187, v185, s40
    v_perm_b32 v27, v191, v189, s40
    v_perm_b32 v28, v179, v177, s41
    v_perm_b32 v29, v183, v181, s41
    v_perm_b32 v30, v187, v185, s41
    v_perm_b32 v31, v191, v189, s41
    s_nop 1
    v_mfma_f32_32x32x16_bf16 v[48:63], v[16:19], v[124:127], v[48:63]
    v_mfma_f32_32x32x16_bf16 v[64:79], v[20:23], v[124:127], v[64:79]
    v_mfma_f32_32x32x16_bf16 v[80:95], v[24:27], v[124:127], v[80:95]
    v_mfma_f32_32x32x16_bf16 v[96:111], v[28:31], v[124:127], v[96:111]
    s_waitcnt vmcnt(0)
    v_perm_b32 v16, v194, v192, s40
    v_perm_b32 v17, v198, v196, s40
    v_perm_b32 v18, v202, v200, s40
    v_perm_b32 v19, v206, v204, s40
    v_perm_b32 v20, v194, v192, s41
    v_perm_b32 v21, v198, v196, s41
    v_perm_b32 v22, v202, v200, s41
    v_perm_b32 v23, v206, v204, s41
    v_perm_b32 v24, v195, v193, s40
    v_perm_b32 v25, v199, v197, s40
    v_perm_b32 v26, v203, v201, s40
    v_perm_b32 v27, v207, v205, s40
    v_perm_b32 v28, v195, v193, s41
    v_perm_b32 v29, v199, v197, s41
    v_perm_b32 v30, v203, v201, s41
    v_perm_b32 v31, v207, v205, s41
    s_nop 1
    v_mfma_f32_32x32x16_bf16 v[48:63], v[16:19], v[32:35], v[48:63]
    v_mfma_f32_32x32x16_bf16 v[64:79], v[20:23], v[32:35], v[64:79]
    v_mfma_f32_32x32x16_bf16 v[80:95], v[24:27], v[32:35], v[80:95]
    v_mfma_f32_32x32x16_bf16 v[96:111], v[28:31], v[32:35], v[96:111]
    s_cmp_ge_u32 s5, 2
    s_cbranch_scc1 L_skip_k7_kernel
    v_perm_b32 v16, v210, v208, s40
    v_perm_b32 v17, v214, v212, s40
    v_perm_b32 v18, v218, v216, s40
    v_perm_b32 v19, v222, v220, s40
    v_perm_b32 v20, v210, v208, s41
    v_perm_b32 v21, v214, v212, s41
    v_perm_b32 v22, v218, v216, s41
    v_perm_b32 v23, v222, v220, s41
    v_perm_b32 v24, v211, v209, s40
    v_perm_b32 v25, v215, v213, s40
    v_perm_b32 v26, v219, v217, s40
    v_perm_b32 v27, v223, v221, s40
    v_perm_b32 v28, v211, v209, s41
    v_perm_b32 v29, v215, v213, s41
    v_perm_b32 v30, v219, v217, s41
    v_perm_b32 v31, v223, v221, s41
    s_nop 1
    v_mfma_f32_32x32x16_bf16 v[48:63], v[16:19], v[36:39], v[48:63]
    v_mfma_f32_32x32x16_bf16 v[64:79], v[20:23], v[36:39], v[64:79]
    v_mfma_f32_32x32x16_bf16 v[80:95], v[24:27], v[36:39], v[80:95]
    v_mfma_f32_32x32x16_bf16 v[96:111], v[28:31], v[36:39], v[96:111]
L_skip_k7_kernel:
    s_nop 7
    s_nop 7
    s_waitcnt vmcnt(0)
    s_barrier
    v_lshlrev_b32 v9, 4, v2
    s_lshl_b32 s27, s5, 12
    v_add_u32 v10, s27, v9
    ds_write_b128 v10, v[48:51] offset:0
    ds_write_b128 v10, v[64:67] offset:1024
    ds_write_b128 v10, v[80:83] offset:2048
    ds_write_b128 v10, v[96:99] offset:3072
    ds_write_b128 v10, v[52:55] offset:16384
    ds_write_b128 v10, v[68:71] offset:17408
    ds_write_b128 v10, v[84:87] offset:18432
    ds_write_b128 v10, v[100:103] offset:19456
    ds_write_b128 v10, v[56:59] offset:32768
    ds_write_b128 v10, v[72:75] offset:33792
    ds_write_b128 v10, v[88:91] offset:34816
    ds_write_b128 v10, v[104:107] offset:35840
    ds_write_b128 v10, v[60:63] offset:49152
    ds_write_b128 v10, v[76:79] offset:50176
    ds_write_b128 v10, v[92:95] offset:51200
    ds_write_b128 v10, v[108:111] offset:52224
    s_waitcnt lgkmcnt(0)
    s_barrier
    s_lshl_b32 s27, s5, 14
    v_add_u32 v10, s27, v9
    ds_read_b128 v[128:131], v10 offset:0
    ds_read_b128 v[132:135], v10 offset:1024
    ds_read_b128 v[136:139], v10 offset:2048
    ds_read_b128 v[140:143], v10 offset:3072
    ds_read_b128 v[144:147], v10 offset:4096
    ds_read_b128 v[148:151], v10 offset:5120
    ds_read_b128 v[152:155], v10 offset:6144
    ds_read_b128 v[156:159], v10 offset:7168
    ds_read_b128 v[160:163], v10 offset:8192
    ds_read_b128 v[164:167], v10 offset:9216
    ds_read_b128 v[168:171], v10 offset:10240
    ds_read_b128 v[172:175], v10 offset:11264
    ds_read_b128 v[176:179], v10 offset:12288
    ds_read_b128 v[180:183], v10 offset:13312
    ds_read_b128 v[184:187], v10 offset:14336
    ds_read_b128 v[188:191], v10 offset:15360
    s_waitcnt lgkmcnt(0)
    v_add_f32 v48, v128, v144
    v_add_f32 v64, v160, v176
    v_add_f32 v49, v129, v145
    v_add_f32 v65, v161, v177
    v_add_f32 v50, v130, v146
    v_add_f32 v66, v162, v178
    v_add_f32 v51, v131, v147
    v_add_f32 v67, v163, v179
    v_add_f32 v52, v132, v148
    v_add_f32 v68, v164, v180
    v_add_f32 v53, v133, v149
    v_add_f32 v69, v165, v181
    v_add_f32 v54, v134, v150
    v_add_f32 v70, v166, v182
    v_add_f32 v55, v135, v151
    v_add_f32 v71, v167, v183
    v_add_f32 v56, v136, v152
    v_add_f32 v72, v168, v184
    v_add_f32 v57, v137, v153
    v_add_f32 v73, v169, v185
    v_add_f32 v58, v138, v154
    v_add_f32 v74, v170, v186
    v_add_f32 v59, v139, v155
    v_add_f32 v75, v171, v187
    v_add_f32 v60, v140, v156
    v_add_f32 v76, v172, v188
    v_add_f32 v61, v141, v157
    v_add_f32 v77, v173, v189
    v_add_f32 v62, v142, v158
    v_add_f32 v78, v174, v190
    v_add_f32 v63, v143, v159
    v_add_f32 v79, v175, v191
    v_add_f32 v48, v48, v64
    v_add_f32 v49, v49, v65
    v_add_f32 v50, v50, v66
    v_add_f32 v51, v51, v67
    v_add_f32 v52, v52, v68
    v_add_f32 v53, v53, v69
    v_add_f32 v54, v54, v70
    v_add_f32 v55, v55, v71
    v_add_f32 v56, v56, v72
    v_add_f32 v57, v57, v73
    v_add_f32 v58, v58, v74
    v_add_f32 v59, v59, v75
    v_add_f32 v60, v60, v76
    v_add_f32 v61, v61, v77
    v_add_f32 v62, v62, v78
    v_add_f32 v63, v63, v79
    v_add_u32 v8, s24, v3
    s_lshl_b32 s27, s4, 8
    s_lshl_b32 s28, s5, 6
    s_add_u32 s27, s27, s28
    v_lshlrev_b32 v9, 5, v4
    v_add_u32 v9, s27, v9
    v_mul_u32_u24 v10, 1024, v8
    v_add_u32 v10, v10, v9
    s_add_u32 s28, s6, 0xe00000
    s_addc_u32 s29, s7, 0
    s_mov_b32 s30, 0x200000
    s_mov_b32 s31, 0x00020000
    buffer_load_dwordx4 v[24:27], v10, s[28:31], 0 offen
    buffer_load_dwordx4 v[28:31], v10, s[28:31], 0 offen offset:16
    s_waitcnt vmcnt(0)
    v_lshlrev_b32 v11, 16, v24
    v_add_f32 v48, v48, v11
    v_and_b32 v11, 0xffff0000, v24
    v_add_f32 v52, v52, v11
    v_lshlrev_b32 v11, 16, v25
    v_add_f32 v56, v56, v11
    v_and_b32 v11, 0xffff0000, v25
    v_add_f32 v60, v60, v11
    v_lshlrev_b32 v11, 16, v26
    v_add_f32 v49, v49, v11
    v_and_b32 v11, 0xffff0000, v26
    v_add_f32 v53, v53, v11
    v_lshlrev_b32 v11, 16, v27
    v_add_f32 v57, v57, v11
    v_and_b32 v11, 0xffff0000, v27
    v_add_f32 v61, v61, v11
    v_lshlrev_b32 v11, 16, v28
    v_add_f32 v50, v50, v11
    v_and_b32 v11, 0xffff0000, v28
    v_add_f32 v54, v54, v11
    v_lshlrev_b32 v11, 16, v29
    v_add_f32 v58, v58, v11
    v_and_b32 v11, 0xffff0000, v29
    v_add_f32 v62, v62, v11
    v_lshlrev_b32 v11, 16, v30
    v_add_f32 v51, v51, v11
    v_and_b32 v11, 0xffff0000, v30
    v_add_f32 v55, v55, v11
    v_lshlrev_b32 v11, 16, v31
    v_add_f32 v59, v59, v11
    v_and_b32 v11, 0xffff0000, v31
    v_add_f32 v63, v63, v11
    s_add_u32 s28, s6, 0x800000
    s_addc_u32 s29, s7, 0
    s_mov_b32 s30, 0x200000
    s_mov_b32 s31, 0x00020000
    buffer_load_dwordx4 v[24:27], v10, s[28:31], 0 offen
    buffer_load_dwordx4 v[28:31], v10, s[28:31], 0 offen offset:16
    s_waitcnt vmcnt(0)
    v_lshlrev_b32 v11, 16, v24
    v_add_f32 v48, v48, v11
    v_and_b32 v11, 0xffff0000, v24
    v_add_f32 v52, v52, v11
    v_lshlrev_b32 v11, 16, v25
    v_add_f32 v56, v56, v11
    v_and_b32 v11, 0xffff0000, v25
    v_add_f32 v60, v60, v11
    v_lshlrev_b32 v11, 16, v26
    v_add_f32 v49, v49, v11
    v_and_b32 v11, 0xffff0000, v26
    v_add_f32 v53, v53, v11
    v_lshlrev_b32 v11, 16, v27
    v_add_f32 v57, v57, v11
    v_and_b32 v11, 0xffff0000, v27
    v_add_f32 v61, v61, v11
    v_lshlrev_b32 v11, 16, v28
    v_add_f32 v50, v50, v11
    v_and_b32 v11, 0xffff0000, v28
    v_add_f32 v54, v54, v11
    v_lshlrev_b32 v11, 16, v29
    v_add_f32 v58, v58, v11
    v_and_b32 v11, 0xffff0000, v29
    v_add_f32 v62, v62, v11
    v_lshlrev_b32 v11, 16, v30
    v_add_f32 v51, v51, v11
    v_and_b32 v11, 0xffff0000, v30
    v_add_f32 v55, v55, v11
    v_lshlrev_b32 v11, 16, v31
    v_add_f32 v59, v59, v11
    v_and_b32 v11, 0xffff0000, v31
    v_add_f32 v63, v63, v11
    s_mov_b32 s28, s12
    s_mov_b32 s29, s13
    s_mov_b32 s30, 0x200000
    s_mov_b32 s31, 0x00020000
    v_cvt_pk_bf16_f32 v16, v48, v52
    v_cvt_pk_bf16_f32 v17, v56, v60
    v_cvt_pk_bf16_f32 v18, v49, v53
    v_cvt_pk_bf16_f32 v19, v57, v61
    v_cvt_pk_bf16_f32 v20, v50, v54
    v_cvt_pk_bf16_f32 v21, v58, v62
    v_cvt_pk_bf16_f32 v22, v51, v55
    v_cvt_pk_bf16_f32 v23, v59, v63
    buffer_store_dwordx4 v[16:19], v10, s[28:31], 0 offen
    buffer_store_dwordx4 v[20:23], v10, s[28:31], 0 offen offset:16
L_end_k7_kernel:
    s_endpgm
.section .rodata,"a"
.p2align 6
.amdhsa_kernel k7_kernel
  .amdhsa_next_free_vgpr 256
  .amdhsa_next_free_sgpr 96
  .amdhsa_accum_offset 256
  .amdhsa_group_segment_fixed_size 0
  .amdhsa_kernarg_size 88
  .amdhsa_user_sgpr_count 2
  .amdhsa_user_sgpr_kernarg_segment_ptr 1
  .amdhsa_system_sgpr_workgroup_id_x 1
.end_amdhsa_kernel
.text
```
